```python
import torch

def _softmax(x, axis=-1):
    return torch.softmax(x, dim=axis)
def _gelu(x):
    return torch.nn.functional.gelu(x, approximate="tanh")
def _silu(x):
    return torch.nn.functional.silu(x)
def _sigmoid(x):
    return torch.sigmoid(x)
def _layernorm(x, axis=-1, eps=1e-5):
    m = x.mean(dim=axis, keepdim=True)
    v = x.var(dim=axis, keepdim=True, unbiased=False)
    return (x - m) / torch.sqrt(v + eps)
def _scatter_add(tgt, idx, src, axis=0):
    return tgt.clone().index_add_(axis, idx, src)
def _segment_sum(src, seg, n):
    out = torch.zeros((n,) + src.shape[1:], dtype=src.dtype)
    return out.index_add_(0, seg, src)
def _pad(x, pw):
    flat = tuple(v for pair in reversed(pw) for v in pair)
    return torch.nn.functional.pad(x, flat)

kernel_name = 'gated_mix__ssm_conv_h3__glu_gated_geglu__prompt'

def setup_inputs():

    _w = (lambda a: (lambda t: t.to(torch.bfloat16) if t.is_floating_point() else t)(torch.as_tensor(a)))
    def _A_setup():
        B, S, D = 1, 2048, 512
        ks = 4
        return {
            "q": _w((lambda *s: torch.randn(*s, dtype=torch.bfloat16) * 0.05)(B, S, D)),
            "k": _w((lambda *s: torch.randn(*s, dtype=torch.bfloat16) * 0.05)(B, S, D)),
            "v": _w((lambda *s: torch.randn(*s, dtype=torch.bfloat16) * 0.05)(B, S, D)),
            "shift_k": _w((lambda *s: torch.randn(*s, dtype=torch.bfloat16) * 0.05)(D, ks) * 0.5),
            "ssm_k": _w((lambda *s: torch.randn(*s, dtype=torch.bfloat16) * 0.05)(D, S) * (1.0 / S ** 0.5)),
            "ssm_D": _w((lambda *s: torch.randn(*s, dtype=torch.bfloat16) * 0.05)(D)),
        }
    _A_in = _A_setup()

    def _B_setup():
        B, S, Dm, Df = 1, 2048, 512, 1792
        return {
            "x": _w((lambda *s: torch.randn(*s, dtype=torch.bfloat16) * 0.05)(B, S, Dm)),
            "w_gate": _w((lambda *s: torch.randn(*s, dtype=torch.bfloat16) * 0.1)(Dm, Df) * (Dm ** -0.5)),
            "w_up": _w((lambda *s: torch.randn(*s, dtype=torch.bfloat16) * 0.1)(Dm, Df) * (Dm ** -0.5)),
            "w_down": _w((lambda *s: torch.randn(*s, dtype=torch.bfloat16) * 0.1)(Df, Dm) * (Df ** -0.5)),
        }
    _B_in = _B_setup()

    return {
        "A_q": _A_in["q"],
        "A_k": _A_in["k"],
        "A_v": _A_in["v"],
        "A_shift_k": _A_in["shift_k"],
        "A_ssm_k": _A_in["ssm_k"],
        "A_ssm_D": _A_in["ssm_D"],
        "B_x": _B_in["x"],
        "B_w_gate": _B_in["w_gate"],
        "B_w_up": _B_in["w_up"],
        "B_w_down": _B_in["w_down"],
        "gate_w": _w((lambda *s: torch.randn(*s, dtype=torch.bfloat16) * 0.05)(512) * 16.0),
    }

def reference(A_q, A_k, A_v, A_shift_k, A_ssm_k, A_ssm_D, B_x, B_w_gate, B_w_up, B_w_down, gate_w):
    def _A_ref(q, k, v, shift_k, ssm_k, ssm_D):
        B, S, D = q.shape
        ks = shift_k.shape[-1]
        k_pad = _pad(k, ((0, 0), (ks - 1, 0), (0, 0)))
        k_shift = torch.zeros_like(k)
        for t in range(ks):
            k_shift = k_shift + k_pad[:, t:t + S, :] * shift_k[:, ks - 1 - t][None, None, :]
        kv = k_shift * v
        L = 2 * S
        kv_pad = _pad(kv, ((0, 0), (0, S), (0, 0)))
        kf_pad = _pad(ssm_k, ((0, 0), (0, S)))
        kv_f = (lambda x, axes=(-2,-1): torch.fft.rfft2(x.float(), dim=axes))(kv_pad[:, None, :, :], axes=(1, 2))
        kf_f = (lambda x, axes=(-2,-1): torch.fft.rfft2(x.float(), dim=axes))(kf_pad[:, None, :], axes=(1, 2))
        kf_f = (lambda x, *d: x.permute(*d))(kf_f, 1, 2, 0)
        y_f = kv_f * kf_f[None, :, :, :]
        y = (lambda x, s, axes=(-2,-1): torch.fft.irfft2(x, s=s, dim=axes).to(torch.bfloat16))(y_f, (1, L), axes=(1, 2))[:, 0, :S, :]
        y = y + kv * ssm_D[None, None, :]
        return q * y

    def _B_ref(x, w_gate, w_up, w_down):
        g = torch.einsum("bsd,df->bsf", x, w_gate)
        u = torch.einsum("bsd,df->bsf", x, w_up)
        h = _gelu(g) * u
        return torch.einsum("bsf,fd->bsd", h, w_down)

    x = A_q
    g = _sigmoid((x * gate_w).sum(-1, keepdims=True))
    a = _A_ref(x, A_k, A_v, A_shift_k, A_ssm_k, A_ssm_D)
    b = _B_ref(x, B_w_gate, B_w_up, B_w_down)
    return g * a + (1 - g) * b
```

```asm
; @launch grid=(256,1,1) block=(512,1,1) lds=163840
.amdgcn_target "amdgcn-amd-amdhsa--gfx950"
.text
.globl gated_mix__ssm_conv_h3__glu_gated_geglu__prompt_kernel
.p2align 8
.type gated_mix__ssm_conv_h3__glu_gated_geglu__prompt_kernel,@function
gated_mix__ssm_conv_h3__glu_gated_geglu__prompt_kernel:

    s_load_dwordx16 s[4:19], s[0:1], 0
    s_load_dwordx8 s[20:27], s[0:1], 64
    s_load_dwordx4 s[28:31], s[0:1], 96
    s_cmp_ge_u32 s2, 256
    s_cbranch_scc1 L_end
    v_lshrrev_b32 v1, 6, v0
    v_and_b32 v0, 63, v0
    v_readfirstlane_b32 s33, v1
    s_nop 3
    s_cmp_ge_u32 s33, 4
    s_cbranch_scc1 L_aux
    s_and_b32 s34, s2, 7
    s_lshl_b32 s34, s34, 7
    s_lshr_b32 s35, s2, 3
    s_lshl_b32 s35, s35, 16
    s_lshl_b32 s36, s33, 14
    s_add_u32 s35, s35, s36
    s_add_u32 s35, s35, s34
    v_and_b32 v185, 7, v0
    v_lshlrev_b32 v185, 4, v185
    v_lshrrev_b32 v186, 3, v0
    v_lshlrev_b32 v184, 11, v186
    v_add3_u32 v184, v184, v185, s35
    v_add_u32 v232, 4294964224, v184
    v_add_u32 v233, 4294965248, v184
    v_add_u32 v234, 4294966272, v184
    s_waitcnt lgkmcnt(0)
    s_mov_b32 s48, s6
    s_mov_b32 s49, s7
    s_mov_b32 s50, 2097152
    s_mov_b32 s51, 0x20000
    buffer_load_dwordx4 v[188:191], v232, s[48:51], 0 offen
    buffer_load_dwordx4 v[192:195], v233, s[48:51], 0 offen
    buffer_load_dwordx4 v[196:199], v234, s[48:51], 0 offen
    buffer_load_dwordx4 v[200:203], v184, s[48:51], 0 offen
    buffer_load_dwordx4 v[204:207], v184, s[48:51], 0 offen offset:1024
    s_mov_b32 s52, s8
    s_mov_b32 s53, s9
    s_mov_b32 s54, 2097152
    s_mov_b32 s55, 0x20000
    buffer_load_dwordx4 v[208:211], v184, s[52:55], 0 offen
    buffer_load_dwordx4 v[212:215], v184, s[52:55], 0 offen offset:1024
    s_mov_b32 s56, s10
    s_mov_b32 s57, s11
    s_mov_b32 s58, 4096
    s_mov_b32 s59, 0x20000
    v_add_u32 v185, s34, v185
    v_lshlrev_b32 v185, 2, v185
    buffer_load_dwordx4 v[216:219], v185, s[56:59], 0 offen offset:0
    buffer_load_dwordx4 v[220:223], v185, s[56:59], 0 offen offset:16
    buffer_load_dwordx4 v[224:227], v185, s[56:59], 0 offen offset:32
    buffer_load_dwordx4 v[228:231], v185, s[56:59], 0 offen offset:48
    s_lshl_b32 s34, s33, 3
    v_add_u32 v186, s34, v186
    v_sub_u32 v186, 31, v186
    v_and_b32 v185, 7, v0
    v_lshlrev_b32 v235, 2, v185
    v_xor_b32 v186, v186, v235
    v_lshlrev_b32 v186, 2, v186
    v_lshl_add_u32 v235, v185, 10, v186
    v_add_u32 v235, 135936, v235
    s_cmp_lg_u32 s33, 3
    s_cbranch_scc1 CP_1
    s_getpc_b64 s[34:35]
L_pcref:
    s_lshr_b32 s36, s2, 3
    s_mul_i32 s36, s36, 576
    s_add_u32 s34, s34, s36
    s_addc_u32 s35, s35, 0
    s_load_dword s32, s[34:35], 0
    s_load_dword s32, s[34:35], 64
    s_load_dword s32, s[34:35], 128
    s_load_dword s32, s[34:35], 192
    s_load_dword s32, s[34:35], 256
    s_load_dword s32, s[34:35], 320
    s_load_dword s32, s[34:35], 384
    s_load_dword s32, s[34:35], 448
    s_load_dword s32, s[34:35], 512
CP_1:
    s_and_b32 s34, s2, 7
    s_lshr_b32 s35, s2, 3
    s_and_b32 s68, s34, 1
    s_lshl_b32 s68, s68, 3
    s_and_b32 s36, s35, 7
    s_add_u32 s68, s68, s36
    s_lshr_b32 s69, s34, 1
    s_lshl_b32 s69, s69, 2
    s_lshr_b32 s36, s35, 3
    s_add_u32 s69, s69, s36
    s_and_b32 s73, s33, 1
    s_lshl_b32 s73, s73, 1
    s_lshr_b32 s34, s33, 1
    s_or_b32 s73, s73, s34
    s_xor_b32 s74, s73, 1
    v_and_b32 v174, 31, v0
    v_lshrrev_b32 v175, 5, v0
    v_bfe_u32 v176, v0, 1, 3
    v_xor_b32 v175, v175, v176
    v_lshlrev_b32 v175, 4, v175
    v_lshl_add_u32 v174, v174, 7, v175
    s_lshl_b32 s34, s73, 12
    v_xor_b32 v164, 0, v174
    v_add_u32 v164, s34, v164
    v_xor_b32 v165, 32, v174
    v_add_u32 v165, s34, v165
    v_xor_b32 v166, 64, v174
    v_add_u32 v166, s34, v166
    v_xor_b32 v167, 96, v174
    v_add_u32 v167, s34, v167
    s_lshl_b32 s34, s74, 12
    v_xor_b32 v168, 0, v174
    v_add_u32 v168, s34, v168
    v_xor_b32 v169, 32, v174
    v_add_u32 v169, s34, v169
    v_xor_b32 v170, 64, v174
    v_add_u32 v170, s34, v170
    v_xor_b32 v171, 96, v174
    v_add_u32 v171, s34, v171
    v_lshrrev_b32 v174, 5, v0
    v_lshlrev_b32 v174, 3, v174
    v_bfe_u32 v175, v0, 2, 2
    v_add_u32 v174, v174, v175
    v_mul_u32_u24 v174, 224, v174
    v_bfe_u32 v175, v0, 4, 1
    v_lshl_add_u32 v174, v175, 4, v174
    v_and_b32 v175, 1, v0
    v_lshl_add_u32 v174, v175, 3, v174
    v_bfe_u32 v175, v0, 1, 1
    v_mul_u32_u24 v175, 14464, v175
    v_add_u32 v174, v174, v175
    v_add_u32 v173, 16480, v174
    s_lshr_b32 s34, s33, 1
    s_lshl_b32 s34, s34, 7
    s_add_u32 s34, s34, 16384
    v_add_u32 v172, s34, v174
    v_mov_b32 v4, 0
    v_mov_b32 v5, 0
    v_mov_b32 v6, 0
    v_mov_b32 v7, 0
    v_mov_b32 v8, 0
    v_mov_b32 v9, 0
    v_mov_b32 v10, 0
    v_mov_b32 v11, 0
    v_mov_b32 v12, 0
    v_mov_b32 v13, 0
    v_mov_b32 v14, 0
    v_mov_b32 v15, 0
    v_mov_b32 v16, 0
    v_mov_b32 v17, 0
    v_mov_b32 v18, 0
    v_mov_b32 v19, 0
    v_mov_b32 v20, 0
    v_mov_b32 v21, 0
    v_mov_b32 v22, 0
    v_mov_b32 v23, 0
    v_mov_b32 v24, 0
    v_mov_b32 v25, 0
    v_mov_b32 v26, 0
    v_mov_b32 v27, 0
    v_mov_b32 v28, 0
    v_mov_b32 v29, 0
    v_mov_b32 v30, 0
    v_mov_b32 v31, 0
    v_mov_b32 v32, 0
    v_mov_b32 v33, 0
    v_mov_b32 v34, 0
    v_mov_b32 v35, 0
    v_mov_b32 v36, 0
    v_mov_b32 v37, 0
    v_mov_b32 v38, 0
    v_mov_b32 v39, 0
    v_mov_b32 v40, 0
    v_mov_b32 v41, 0
    v_mov_b32 v42, 0
    v_mov_b32 v43, 0
    v_mov_b32 v44, 0
    v_mov_b32 v45, 0
    v_mov_b32 v46, 0
    v_mov_b32 v47, 0
    v_mov_b32 v48, 0
    v_mov_b32 v49, 0
    v_mov_b32 v50, 0
    v_mov_b32 v51, 0
    v_mov_b32 v52, 0
    v_mov_b32 v53, 0
    v_mov_b32 v54, 0
    v_mov_b32 v55, 0
    v_mov_b32 v56, 0
    v_mov_b32 v57, 0
    v_mov_b32 v58, 0
    v_mov_b32 v59, 0
    v_mov_b32 v60, 0
    v_mov_b32 v61, 0
    v_mov_b32 v62, 0
    v_mov_b32 v63, 0
    v_mov_b32 v64, 0
    v_mov_b32 v65, 0
    v_mov_b32 v66, 0
    v_mov_b32 v67, 0
    v_mov_b32 v68, 0
    v_mov_b32 v69, 0
    v_mov_b32 v70, 0
    v_mov_b32 v71, 0
    v_mov_b32 v72, 0
    v_mov_b32 v73, 0
    v_mov_b32 v74, 0
    v_mov_b32 v75, 0
    v_mov_b32 v76, 0
    v_mov_b32 v77, 0
    v_mov_b32 v78, 0
    v_mov_b32 v79, 0
    v_mov_b32 v80, 0
    v_mov_b32 v81, 0
    v_mov_b32 v82, 0
    v_mov_b32 v83, 0
    v_mov_b32 v84, 0
    v_mov_b32 v85, 0
    v_mov_b32 v86, 0
    v_mov_b32 v87, 0
    v_mov_b32 v88, 0
    v_mov_b32 v89, 0
    v_mov_b32 v90, 0
    v_mov_b32 v91, 0
    v_mov_b32 v92, 0
    v_mov_b32 v93, 0
    v_mov_b32 v94, 0
    v_mov_b32 v95, 0
    v_mov_b32 v96, 0
    v_mov_b32 v97, 0
    v_mov_b32 v98, 0
    v_mov_b32 v99, 0
    v_mov_b32 v100, 0
    v_mov_b32 v101, 0
    v_mov_b32 v102, 0
    v_mov_b32 v103, 0
    v_mov_b32 v104, 0
    v_mov_b32 v105, 0
    v_mov_b32 v106, 0
    v_mov_b32 v107, 0
    v_mov_b32 v108, 0
    v_mov_b32 v109, 0
    v_mov_b32 v110, 0
    v_mov_b32 v111, 0
    v_mov_b32 v112, 0
    v_mov_b32 v113, 0
    v_mov_b32 v114, 0
    v_mov_b32 v115, 0
    s_waitcnt vmcnt(0)
    v_lshlrev_b32 v116, 16, v188
    v_and_b32 v117, 0xffff0000, v188
    v_lshlrev_b32 v118, 16, v192
    v_and_b32 v119, 0xffff0000, v192
    v_lshlrev_b32 v120, 16, v196
    v_and_b32 v121, 0xffff0000, v196
    v_lshlrev_b32 v122, 16, v200
    v_and_b32 v123, 0xffff0000, v200
    v_lshlrev_b32 v124, 16, v204
    v_and_b32 v125, 0xffff0000, v204
    v_lshlrev_b32 v126, 16, v208
    v_and_b32 v127, 0xffff0000, v208
    v_lshlrev_b32 v128, 16, v212
    v_and_b32 v129, 0xffff0000, v212
    v_lshlrev_b32 v130, 16, v216
    v_and_b32 v132, 0xffff0000, v216
    v_lshlrev_b32 v134, 16, v217
    v_and_b32 v136, 0xffff0000, v217
    v_lshlrev_b32 v131, 16, v218
    v_and_b32 v133, 0xffff0000, v218
    v_lshlrev_b32 v135, 16, v219
    v_and_b32 v137, 0xffff0000, v219
    v_pk_mul_f32 v[138:139], v[116:117], v[136:137]
    v_pk_mul_f32 v[140:141], v[118:119], v[136:137]
    v_pk_fma_f32 v[138:139], v[118:119], v[134:135], v[138:139]
    v_pk_fma_f32 v[140:141], v[120:121], v[134:135], v[140:141]
    v_pk_fma_f32 v[138:139], v[120:121], v[132:133], v[138:139]
    v_pk_fma_f32 v[140:141], v[122:123], v[132:133], v[140:141]
    v_pk_fma_f32 v[138:139], v[122:123], v[130:131], v[138:139]
    v_pk_fma_f32 v[140:141], v[124:125], v[130:131], v[140:141]
    v_pk_mul_f32 v[138:139], v[138:139], v[126:127]
    v_pk_mul_f32 v[140:141], v[140:141], v[128:129]
    v_cvt_pk_bf16_f32 v142, v140, v138
    v_cvt_pk_bf16_f32 v143, v141, v139
    ds_write_b32 v235, v142 offset:0
    ds_write_b32 v235, v143 offset:128
    v_lshlrev_b32 v116, 16, v189
    v_and_b32 v117, 0xffff0000, v189
    v_lshlrev_b32 v118, 16, v193
    v_and_b32 v119, 0xffff0000, v193
    v_lshlrev_b32 v120, 16, v197
    v_and_b32 v121, 0xffff0000, v197
    v_lshlrev_b32 v122, 16, v201
    v_and_b32 v123, 0xffff0000, v201
    v_lshlrev_b32 v124, 16, v205
    v_and_b32 v125, 0xffff0000, v205
    v_lshlrev_b32 v126, 16, v209
    v_and_b32 v127, 0xffff0000, v209
    v_lshlrev_b32 v128, 16, v213
    v_and_b32 v129, 0xffff0000, v213
    v_lshlrev_b32 v130, 16, v220
    v_and_b32 v132, 0xffff0000, v220
    v_lshlrev_b32 v134, 16, v221
    v_and_b32 v136, 0xffff0000, v221
    v_lshlrev_b32 v131, 16, v222
    v_and_b32 v133, 0xffff0000, v222
    v_lshlrev_b32 v135, 16, v223
    v_and_b32 v137, 0xffff0000, v223
    v_pk_mul_f32 v[138:139], v[116:117], v[136:137]
    v_pk_mul_f32 v[140:141], v[118:119], v[136:137]
    v_pk_fma_f32 v[138:139], v[118:119], v[134:135], v[138:139]
    v_pk_fma_f32 v[140:141], v[120:121], v[134:135], v[140:141]
    v_pk_fma_f32 v[138:139], v[120:121], v[132:133], v[138:139]
    v_pk_fma_f32 v[140:141], v[122:123], v[132:133], v[140:141]
    v_pk_fma_f32 v[138:139], v[122:123], v[130:131], v[138:139]
    v_pk_fma_f32 v[140:141], v[124:125], v[130:131], v[140:141]
    v_pk_mul_f32 v[138:139], v[138:139], v[126:127]
    v_pk_mul_f32 v[140:141], v[140:141], v[128:129]
    v_cvt_pk_bf16_f32 v142, v140, v138
    v_cvt_pk_bf16_f32 v143, v141, v139
    ds_write_b32 v235, v142 offset:256
    ds_write_b32 v235, v143 offset:384
    v_lshlrev_b32 v116, 16, v190
    v_and_b32 v117, 0xffff0000, v190
    v_lshlrev_b32 v118, 16, v194
    v_and_b32 v119, 0xffff0000, v194
    v_lshlrev_b32 v120, 16, v198
    v_and_b32 v121, 0xffff0000, v198
    v_lshlrev_b32 v122, 16, v202
    v_and_b32 v123, 0xffff0000, v202
    v_lshlrev_b32 v124, 16, v206
    v_and_b32 v125, 0xffff0000, v206
    v_lshlrev_b32 v126, 16, v210
    v_and_b32 v127, 0xffff0000, v210
    v_lshlrev_b32 v128, 16, v214
    v_and_b32 v129, 0xffff0000, v214
    v_lshlrev_b32 v130, 16, v224
    v_and_b32 v132, 0xffff0000, v224
    v_lshlrev_b32 v134, 16, v225
    v_and_b32 v136, 0xffff0000, v225
    v_lshlrev_b32 v131, 16, v226
    v_and_b32 v133, 0xffff0000, v226
    v_lshlrev_b32 v135, 16, v227
    v_and_b32 v137, 0xffff0000, v227
    v_pk_mul_f32 v[138:139], v[116:117], v[136:137]
    v_pk_mul_f32 v[140:141], v[118:119], v[136:137]
    v_pk_fma_f32 v[138:139], v[118:119], v[134:135], v[138:139]
    v_pk_fma_f32 v[140:141], v[120:121], v[134:135], v[140:141]
    v_pk_fma_f32 v[138:139], v[120:121], v[132:133], v[138:139]
    v_pk_fma_f32 v[140:141], v[122:123], v[132:133], v[140:141]
    v_pk_fma_f32 v[138:139], v[122:123], v[130:131], v[138:139]
    v_pk_fma_f32 v[140:141], v[124:125], v[130:131], v[140:141]
    v_pk_mul_f32 v[138:139], v[138:139], v[126:127]
    v_pk_mul_f32 v[140:141], v[140:141], v[128:129]
    v_cvt_pk_bf16_f32 v142, v140, v138
    v_cvt_pk_bf16_f32 v143, v141, v139
    ds_write_b32 v235, v142 offset:512
    ds_write_b32 v235, v143 offset:640
    v_lshlrev_b32 v116, 16, v191
    v_and_b32 v117, 0xffff0000, v191
    v_lshlrev_b32 v118, 16, v195
    v_and_b32 v119, 0xffff0000, v195
    v_lshlrev_b32 v120, 16, v199
    v_and_b32 v121, 0xffff0000, v199
    v_lshlrev_b32 v122, 16, v203
    v_and_b32 v123, 0xffff0000, v203
    v_lshlrev_b32 v124, 16, v207
    v_and_b32 v125, 0xffff0000, v207
    v_lshlrev_b32 v126, 16, v211
    v_and_b32 v127, 0xffff0000, v211
    v_lshlrev_b32 v128, 16, v215
    v_and_b32 v129, 0xffff0000, v215
    v_lshlrev_b32 v130, 16, v228
    v_and_b32 v132, 0xffff0000, v228
    v_lshlrev_b32 v134, 16, v229
    v_and_b32 v136, 0xffff0000, v229
    v_lshlrev_b32 v131, 16, v230
    v_and_b32 v133, 0xffff0000, v230
    v_lshlrev_b32 v135, 16, v231
    v_and_b32 v137, 0xffff0000, v231
    v_pk_mul_f32 v[138:139], v[116:117], v[136:137]
    v_pk_mul_f32 v[140:141], v[118:119], v[136:137]
    v_pk_fma_f32 v[138:139], v[118:119], v[134:135], v[138:139]
    v_pk_fma_f32 v[140:141], v[120:121], v[134:135], v[140:141]
    v_pk_fma_f32 v[138:139], v[120:121], v[132:133], v[138:139]
    v_pk_fma_f32 v[140:141], v[122:123], v[132:133], v[140:141]
    v_pk_fma_f32 v[138:139], v[122:123], v[130:131], v[138:139]
    v_pk_fma_f32 v[140:141], v[124:125], v[130:131], v[140:141]
    v_pk_mul_f32 v[138:139], v[138:139], v[126:127]
    v_pk_mul_f32 v[140:141], v[140:141], v[128:129]
    v_cvt_pk_bf16_f32 v142, v140, v138
    v_cvt_pk_bf16_f32 v143, v141, v139
    ds_write_b32 v235, v142 offset:768
    ds_write_b32 v235, v143 offset:896
    s_waitcnt lgkmcnt(0)
    s_barrier
    ds_read_b128 v[148:151], v164
    ds_read_b64_tr_b16 v[116:117], v172 offset:0
    ds_read_b64_tr_b16 v[118:119], v172 offset:896
    ds_read_b128 v[152:155], v168
    ds_read_b64_tr_b16 v[120:121], v172 offset:32
    ds_read_b64_tr_b16 v[122:123], v172 offset:928
    ds_read_b64_tr_b16 v[124:125], v172 offset:64
    ds_read_b64_tr_b16 v[126:127], v172 offset:960
    ds_read_b64_tr_b16 v[128:129], v173 offset:0
    ds_read_b64_tr_b16 v[130:131], v173 offset:896
    s_mov_b32 s70, 0
    s_mov_b32 s71, 0
P1C_2:
    s_waitcnt lgkmcnt(0)
    v_mfma_f32_32x32x16_bf16 v[4:19], v[116:119], v[148:151], v[4:19]
    ds_read_b128 v[156:159], v165
    ds_read_b64_tr_b16 v[132:133], v172 offset:3584
    v_mfma_f32_32x32x16_bf16 v[20:35], v[116:119], v[152:155], v[20:35]
    ds_read_b64_tr_b16 v[134:135], v172 offset:4480
    ds_read_b128 v[160:163], v169
    v_mfma_f32_32x32x16_bf16 v[36:51], v[120:123], v[148:151], v[36:51]
    ds_read_b64_tr_b16 v[136:137], v172 offset:3616
    ds_read_b64_tr_b16 v[138:139], v172 offset:4512
    v_mfma_f32_32x32x16_bf16 v[52:67], v[120:123], v[152:155], v[52:67]
    ds_read_b64_tr_b16 v[140:141], v172 offset:3648
    ds_read_b64_tr_b16 v[142:143], v172 offset:4544
    v_mfma_f32_32x32x16_bf16 v[68:83], v[124:127], v[148:151], v[68:83]
    ds_read_b64_tr_b16 v[144:145], v173 offset:3584
    ds_read_b64_tr_b16 v[146:147], v173 offset:4480
    v_mfma_f32_32x32x16_bf16 v[84:99], v[124:127], v[152:155], v[84:99]
    v_mfma_f32_32x32x16_bf16 v[100:115], v[128:131], v[148:151], v[100:115]
    s_waitcnt lgkmcnt(0)
    v_mfma_f32_32x32x16_bf16 v[4:19], v[132:135], v[156:159], v[4:19]
    ds_read_b128 v[148:151], v166
    ds_read_b64_tr_b16 v[116:117], v172 offset:7168
    v_mfma_f32_32x32x16_bf16 v[20:35], v[132:135], v[160:163], v[20:35]
    ds_read_b64_tr_b16 v[118:119], v172 offset:8064
    ds_read_b128 v[152:155], v170
    v_mfma_f32_32x32x16_bf16 v[36:51], v[136:139], v[156:159], v[36:51]
    ds_read_b64_tr_b16 v[120:121], v172 offset:7200
    ds_read_b64_tr_b16 v[122:123], v172 offset:8096
    v_mfma_f32_32x32x16_bf16 v[52:67], v[136:139], v[160:163], v[52:67]
    ds_read_b64_tr_b16 v[124:125], v172 offset:7232
    ds_read_b64_tr_b16 v[126:127], v172 offset:8128
    v_mfma_f32_32x32x16_bf16 v[68:83], v[140:143], v[156:159], v[68:83]
    ds_read_b64_tr_b16 v[128:129], v173 offset:7168
    ds_read_b64_tr_b16 v[130:131], v173 offset:8064
    v_mfma_f32_32x32x16_bf16 v[84:99], v[140:143], v[160:163], v[84:99]
    v_mfma_f32_32x32x16_bf16 v[100:115], v[144:147], v[156:159], v[100:115]
    s_waitcnt lgkmcnt(0)
    v_mfma_f32_32x32x16_bf16 v[4:19], v[116:119], v[148:151], v[4:19]
    ds_read_b128 v[156:159], v167
    ds_read_b64_tr_b16 v[132:133], v172 offset:10752
    v_mfma_f32_32x32x16_bf16 v[20:35], v[116:119], v[152:155], v[20:35]
    ds_read_b64_tr_b16 v[134:135], v172 offset:11648
    ds_read_b128 v[160:163], v171
    v_mfma_f32_32x32x16_bf16 v[36:51], v[120:123], v[148:151], v[36:51]
    ds_read_b64_tr_b16 v[136:137], v172 offset:10784
    ds_read_b64_tr_b16 v[138:139], v172 offset:11680
    v_mfma_f32_32x32x16_bf16 v[52:67], v[120:123], v[152:155], v[52:67]
    ds_read_b64_tr_b16 v[140:141], v172 offset:10816
    ds_read_b64_tr_b16 v[142:143], v172 offset:11712
    v_mfma_f32_32x32x16_bf16 v[68:83], v[124:127], v[148:151], v[68:83]
    ds_read_b64_tr_b16 v[144:145], v173 offset:10752
    ds_read_b64_tr_b16 v[146:147], v173 offset:11648
    v_mfma_f32_32x32x16_bf16 v[84:99], v[124:127], v[152:155], v[84:99]
    v_mfma_f32_32x32x16_bf16 v[100:115], v[128:131], v[148:151], v[100:115]
    s_waitcnt lgkmcnt(0)
    v_mfma_f32_32x32x16_bf16 v[4:19], v[132:135], v[156:159], v[4:19]
    s_cmp_eq_u32 s70, 7
    s_cbranch_scc1 P1skip_3
    s_barrier
P1skip_3:
    s_add_u32 s72, s71, 45312
    s_cmp_eq_u32 s72, 135936
    s_cselect_b32 s72, 0, s72
    s_sub_u32 s34, s72, s71
    s_mov_b32 s71, s72
    v_add_u32 v164, s34, v164
    v_add_u32 v168, s34, v168
    v_add_u32 v172, s34, v172
    v_add_u32 v173, s34, v173
    v_mfma_f32_32x32x16_bf16 v[20:35], v[132:135], v[160:163], v[20:35]
    ds_read_b128 v[148:151], v164
    ds_read_b64_tr_b16 v[116:117], v172 offset:0
    v_mfma_f32_32x32x16_bf16 v[36:51], v[136:139], v[156:159], v[36:51]
    v_add_u32 v165, s34, v165
    v_add_u32 v169, s34, v169
    ds_read_b64_tr_b16 v[118:119], v172 offset:896
    ds_read_b128 v[152:155], v168
    v_mfma_f32_32x32x16_bf16 v[52:67], v[136:139], v[160:163], v[52:67]
    v_add_u32 v166, s34, v166
    v_add_u32 v170, s34, v170
    ds_read_b64_tr_b16 v[120:121], v172 offset:32
    ds_read_b64_tr_b16 v[122:123], v172 offset:928
    v_mfma_f32_32x32x16_bf16 v[68:83], v[140:143], v[156:159], v[68:83]
    v_add_u32 v167, s34, v167
    v_add_u32 v171, s34, v171
    ds_read_b64_tr_b16 v[124:125], v172 offset:64
    ds_read_b64_tr_b16 v[126:127], v172 offset:960
    v_mfma_f32_32x32x16_bf16 v[84:99], v[140:143], v[160:163], v[84:99]
    ds_read_b64_tr_b16 v[128:129], v173 offset:0
    ds_read_b64_tr_b16 v[130:131], v173 offset:896
    v_mfma_f32_32x32x16_bf16 v[100:115], v[144:147], v[156:159], v[100:115]
    s_add_u32 s70, s70, 1
    s_cmp_lt_u32 s70, 8
    s_cbranch_scc1 P1C_2
    s_waitcnt lgkmcnt(0)
    s_nop 15
    s_add_u32 s56, s30, 3145728
    s_addc_u32 s57, s31, 0
    s_mov_b32 s58, 7340032
    s_mov_b32 s59, 0x20000
    s_mov_b32 s60, s14
    s_mov_b32 s61, s15
    s_mov_b32 s62, 1024
    s_mov_b32 s63, 0x20000
    s_and_b32 s34, s2, 7
    s_lshl_b32 s34, s34, 5
    s_lshr_b32 s35, s2, 3
    s_add_u32 s34, s34, s35
    s_lshl_b32 s34, s34, 1
    s_lshr_b32 s35, s33, 1
    s_add_u32 s34, s34, s35
    s_lshl_b32 s34, s34, 1
    v_mov_b32 v249, 0
    buffer_load_ushort v249, v249, s[60:63], s34 offen
    v_mov_b32 v178, 0xc0135761
    v_mov_b32 v180, 0xbdd2d3e8
    v_mov_b32 v182, 1.0
    v_mov_b32 v179, 0xc0135761
    v_mov_b32 v181, 0xbdd2d3e8
    v_mov_b32 v183, 1.0
    v_lshlrev_b32 v184, 4, v0
    s_lshl_b32 s34, s68, 2
    s_add_u32 s34, s34, s73
    s_mul_i32 s34, s34, 112
    s_mul_i32 s35, s69, 7
    s_add_u32 s34, s34, s35
    s_lshl_b32 s75, s34, 10
    s_lshl_b32 s34, s68, 2
    s_add_u32 s34, s34, s74
    s_mul_i32 s34, s34, 112
    s_mul_i32 s35, s69, 7
    s_add_u32 s34, s34, s35
    s_lshl_b32 s76, s34, 10
    s_lshr_b32 s77, s33, 1
    s_lshl_b32 s77, s77, 12
    v_pk_mul_f32 v[186:187], v[4:5], v[4:5]
    v_pk_mul_f32 v[188:189], v[6:7], v[6:7]
    v_pk_mul_f32 v[190:191], v[12:13], v[12:13]
    v_pk_mul_f32 v[192:193], v[14:15], v[14:15]
    v_pk_fma_f32 v[186:187], v[186:187], v[180:181], v[178:179]
    v_pk_fma_f32 v[188:189], v[188:189], v[180:181], v[178:179]
    v_pk_fma_f32 v[190:191], v[190:191], v[180:181], v[178:179]
    v_pk_fma_f32 v[192:193], v[192:193], v[180:181], v[178:179]
    v_pk_mul_f32 v[186:187], v[186:187], v[4:5]
    v_pk_mul_f32 v[188:189], v[188:189], v[6:7]
    v_pk_mul_f32 v[190:191], v[190:191], v[12:13]
    v_pk_mul_f32 v[192:193], v[192:193], v[14:15]
    v_exp_f32 v186, v186
    v_exp_f32 v187, v187
    v_exp_f32 v188, v188
    v_exp_f32 v189, v189
    v_exp_f32 v190, v190
    v_exp_f32 v191, v191
    v_exp_f32 v192, v192
    v_exp_f32 v193, v193
    v_pk_mul_f32 v[8:9], v[8:9], v[4:5]
    v_pk_mul_f32 v[10:11], v[10:11], v[6:7]
    v_pk_mul_f32 v[16:17], v[16:17], v[12:13]
    v_pk_mul_f32 v[18:19], v[18:19], v[14:15]
    v_pk_add_f32 v[186:187], v[186:187], v[182:183]
    v_pk_add_f32 v[188:189], v[188:189], v[182:183]
    v_pk_add_f32 v[190:191], v[190:191], v[182:183]
    v_pk_add_f32 v[192:193], v[192:193], v[182:183]
    v_rcp_f32 v186, v186
    v_rcp_f32 v187, v187
    v_rcp_f32 v188, v188
    v_rcp_f32 v189, v189
    v_rcp_f32 v190, v190
    v_rcp_f32 v191, v191
    v_rcp_f32 v192, v192
    v_rcp_f32 v193, v193
    s_nop 0
    v_pk_mul_f32 v[8:9], v[8:9], v[186:187]
    v_pk_mul_f32 v[10:11], v[10:11], v[188:189]
    v_pk_mul_f32 v[16:17], v[16:17], v[190:191]
    v_pk_mul_f32 v[18:19], v[18:19], v[192:193]
    v_cvt_pk_bf16_f32 v204, v8, v9
    v_cvt_pk_bf16_f32 v205, v10, v11
    v_cvt_pk_bf16_f32 v206, v16, v17
    v_cvt_pk_bf16_f32 v207, v18, v19
    s_add_u32 s34, s75, s77
    buffer_store_dwordx4 v[204:207], v184, s[56:59], s34 offen sc1
    v_pk_mul_f32 v[194:195], v[20:21], v[20:21]
    v_pk_mul_f32 v[196:197], v[22:23], v[22:23]
    v_pk_mul_f32 v[198:199], v[28:29], v[28:29]
    v_pk_mul_f32 v[200:201], v[30:31], v[30:31]
    v_pk_fma_f32 v[194:195], v[194:195], v[180:181], v[178:179]
    v_pk_fma_f32 v[196:197], v[196:197], v[180:181], v[178:179]
    v_pk_fma_f32 v[198:199], v[198:199], v[180:181], v[178:179]
    v_pk_fma_f32 v[200:201], v[200:201], v[180:181], v[178:179]
    v_pk_mul_f32 v[194:195], v[194:195], v[20:21]
    v_pk_mul_f32 v[196:197], v[196:197], v[22:23]
    v_pk_mul_f32 v[198:199], v[198:199], v[28:29]
    v_pk_mul_f32 v[200:201], v[200:201], v[30:31]
    v_exp_f32 v194, v194
    v_exp_f32 v195, v195
    v_exp_f32 v196, v196
    v_exp_f32 v197, v197
    v_exp_f32 v198, v198
    v_exp_f32 v199, v199
    v_exp_f32 v200, v200
    v_exp_f32 v201, v201
    v_pk_mul_f32 v[24:25], v[24:25], v[20:21]
    v_pk_mul_f32 v[26:27], v[26:27], v[22:23]
    v_pk_mul_f32 v[32:33], v[32:33], v[28:29]
    v_pk_mul_f32 v[34:35], v[34:35], v[30:31]
    v_pk_add_f32 v[194:195], v[194:195], v[182:183]
    v_pk_add_f32 v[196:197], v[196:197], v[182:183]
    v_pk_add_f32 v[198:199], v[198:199], v[182:183]
    v_pk_add_f32 v[200:201], v[200:201], v[182:183]
    v_rcp_f32 v194, v194
    v_rcp_f32 v195, v195
    v_rcp_f32 v196, v196
    v_rcp_f32 v197, v197
    v_rcp_f32 v198, v198
    v_rcp_f32 v199, v199
    v_rcp_f32 v200, v200
    v_rcp_f32 v201, v201
    s_nop 0
    v_pk_mul_f32 v[24:25], v[24:25], v[194:195]
    v_pk_mul_f32 v[26:27], v[26:27], v[196:197]
    v_pk_mul_f32 v[32:33], v[32:33], v[198:199]
    v_pk_mul_f32 v[34:35], v[34:35], v[200:201]
    v_cvt_pk_bf16_f32 v208, v24, v25
    v_cvt_pk_bf16_f32 v209, v26, v27
    v_cvt_pk_bf16_f32 v210, v32, v33
    v_cvt_pk_bf16_f32 v211, v34, v35
    s_add_u32 s34, s76, s77
    buffer_store_dwordx4 v[208:211], v184, s[56:59], s34 offen sc1
    v_pk_mul_f32 v[186:187], v[36:37], v[36:37]
    v_pk_mul_f32 v[188:189], v[38:39], v[38:39]
    v_pk_mul_f32 v[190:191], v[44:45], v[44:45]
    v_pk_mul_f32 v[192:193], v[46:47], v[46:47]
    v_pk_fma_f32 v[186:187], v[186:187], v[180:181], v[178:179]
    v_pk_fma_f32 v[188:189], v[188:189], v[180:181], v[178:179]
    v_pk_fma_f32 v[190:191], v[190:191], v[180:181], v[178:179]
    v_pk_fma_f32 v[192:193], v[192:193], v[180:181], v[178:179]
    v_pk_mul_f32 v[186:187], v[186:187], v[36:37]
    v_pk_mul_f32 v[188:189], v[188:189], v[38:39]
    v_pk_mul_f32 v[190:191], v[190:191], v[44:45]
    v_pk_mul_f32 v[192:193], v[192:193], v[46:47]
    v_exp_f32 v186, v186
    v_exp_f32 v187, v187
    v_exp_f32 v188, v188
    v_exp_f32 v189, v189
    v_exp_f32 v190, v190
    v_exp_f32 v191, v191
    v_exp_f32 v192, v192
    v_exp_f32 v193, v193
    v_pk_mul_f32 v[40:41], v[40:41], v[36:37]
    v_pk_mul_f32 v[42:43], v[42:43], v[38:39]
    v_pk_mul_f32 v[48:49], v[48:49], v[44:45]
    v_pk_mul_f32 v[50:51], v[50:51], v[46:47]
    v_pk_add_f32 v[186:187], v[186:187], v[182:183]
    v_pk_add_f32 v[188:189], v[188:189], v[182:183]
    v_pk_add_f32 v[190:191], v[190:191], v[182:183]
    v_pk_add_f32 v[192:193], v[192:193], v[182:183]
    v_rcp_f32 v186, v186
    v_rcp_f32 v187, v187
    v_rcp_f32 v188, v188
    v_rcp_f32 v189, v189
    v_rcp_f32 v190, v190
    v_rcp_f32 v191, v191
    v_rcp_f32 v192, v192
    v_rcp_f32 v193, v193
    s_nop 0
    v_pk_mul_f32 v[40:41], v[40:41], v[186:187]
    v_pk_mul_f32 v[42:43], v[42:43], v[188:189]
    v_pk_mul_f32 v[48:49], v[48:49], v[190:191]
    v_pk_mul_f32 v[50:51], v[50:51], v[192:193]
    v_cvt_pk_bf16_f32 v204, v40, v41
    v_cvt_pk_bf16_f32 v205, v42, v43
    v_cvt_pk_bf16_f32 v206, v48, v49
    v_cvt_pk_bf16_f32 v207, v50, v51
    s_add_u32 s34, s75, s77
    s_add_u32 s34, s34, 1024
    buffer_store_dwordx4 v[204:207], v184, s[56:59], s34 offen sc1
    v_pk_mul_f32 v[194:195], v[52:53], v[52:53]
    v_pk_mul_f32 v[196:197], v[54:55], v[54:55]
    v_pk_mul_f32 v[198:199], v[60:61], v[60:61]
    v_pk_mul_f32 v[200:201], v[62:63], v[62:63]
    v_pk_fma_f32 v[194:195], v[194:195], v[180:181], v[178:179]
    v_pk_fma_f32 v[196:197], v[196:197], v[180:181], v[178:179]
    v_pk_fma_f32 v[198:199], v[198:199], v[180:181], v[178:179]
    v_pk_fma_f32 v[200:201], v[200:201], v[180:181], v[178:179]
    v_pk_mul_f32 v[194:195], v[194:195], v[52:53]
    v_pk_mul_f32 v[196:197], v[196:197], v[54:55]
    v_pk_mul_f32 v[198:199], v[198:199], v[60:61]
    v_pk_mul_f32 v[200:201], v[200:201], v[62:63]
    v_exp_f32 v194, v194
    v_exp_f32 v195, v195
    v_exp_f32 v196, v196
    v_exp_f32 v197, v197
    v_exp_f32 v198, v198
    v_exp_f32 v199, v199
    v_exp_f32 v200, v200
    v_exp_f32 v201, v201
    v_pk_mul_f32 v[56:57], v[56:57], v[52:53]
    v_pk_mul_f32 v[58:59], v[58:59], v[54:55]
    v_pk_mul_f32 v[64:65], v[64:65], v[60:61]
    v_pk_mul_f32 v[66:67], v[66:67], v[62:63]
    v_pk_add_f32 v[194:195], v[194:195], v[182:183]
    v_pk_add_f32 v[196:197], v[196:197], v[182:183]
    v_pk_add_f32 v[198:199], v[198:199], v[182:183]
    v_pk_add_f32 v[200:201], v[200:201], v[182:183]
    v_rcp_f32 v194, v194
    v_rcp_f32 v195, v195
    v_rcp_f32 v196, v196
    v_rcp_f32 v197, v197
    v_rcp_f32 v198, v198
    v_rcp_f32 v199, v199
    v_rcp_f32 v200, v200
    v_rcp_f32 v201, v201
    s_nop 0
    v_pk_mul_f32 v[56:57], v[56:57], v[194:195]
    v_pk_mul_f32 v[58:59], v[58:59], v[196:197]
    v_pk_mul_f32 v[64:65], v[64:65], v[198:199]
    v_pk_mul_f32 v[66:67], v[66:67], v[200:201]
    v_cvt_pk_bf16_f32 v208, v56, v57
    v_cvt_pk_bf16_f32 v209, v58, v59
    v_cvt_pk_bf16_f32 v210, v64, v65
    v_cvt_pk_bf16_f32 v211, v66, v67
    s_add_u32 s34, s76, s77
    s_add_u32 s34, s34, 1024
    buffer_store_dwordx4 v[208:211], v184, s[56:59], s34 offen sc1
    v_pk_mul_f32 v[186:187], v[68:69], v[68:69]
    v_pk_mul_f32 v[188:189], v[70:71], v[70:71]
    v_pk_mul_f32 v[190:191], v[76:77], v[76:77]
    v_pk_mul_f32 v[192:193], v[78:79], v[78:79]
    v_pk_fma_f32 v[186:187], v[186:187], v[180:181], v[178:179]
    v_pk_fma_f32 v[188:189], v[188:189], v[180:181], v[178:179]
    v_pk_fma_f32 v[190:191], v[190:191], v[180:181], v[178:179]
    v_pk_fma_f32 v[192:193], v[192:193], v[180:181], v[178:179]
    v_pk_mul_f32 v[186:187], v[186:187], v[68:69]
    v_pk_mul_f32 v[188:189], v[188:189], v[70:71]
    v_pk_mul_f32 v[190:191], v[190:191], v[76:77]
    v_pk_mul_f32 v[192:193], v[192:193], v[78:79]
    v_exp_f32 v186, v186
    v_exp_f32 v187, v187
    v_exp_f32 v188, v188
    v_exp_f32 v189, v189
    v_exp_f32 v190, v190
    v_exp_f32 v191, v191
    v_exp_f32 v192, v192
    v_exp_f32 v193, v193
    v_pk_mul_f32 v[72:73], v[72:73], v[68:69]
    v_pk_mul_f32 v[74:75], v[74:75], v[70:71]
    v_pk_mul_f32 v[80:81], v[80:81], v[76:77]
    v_pk_mul_f32 v[82:83], v[82:83], v[78:79]
    v_pk_add_f32 v[186:187], v[186:187], v[182:183]
    v_pk_add_f32 v[188:189], v[188:189], v[182:183]
    v_pk_add_f32 v[190:191], v[190:191], v[182:183]
    v_pk_add_f32 v[192:193], v[192:193], v[182:183]
    v_rcp_f32 v186, v186
    v_rcp_f32 v187, v187
    v_rcp_f32 v188, v188
    v_rcp_f32 v189, v189
    v_rcp_f32 v190, v190
    v_rcp_f32 v191, v191
    v_rcp_f32 v192, v192
    v_rcp_f32 v193, v193
    s_nop 0
    v_pk_mul_f32 v[72:73], v[72:73], v[186:187]
    v_pk_mul_f32 v[74:75], v[74:75], v[188:189]
    v_pk_mul_f32 v[80:81], v[80:81], v[190:191]
    v_pk_mul_f32 v[82:83], v[82:83], v[192:193]
    v_cvt_pk_bf16_f32 v204, v72, v73
    v_cvt_pk_bf16_f32 v205, v74, v75
    v_cvt_pk_bf16_f32 v206, v80, v81
    v_cvt_pk_bf16_f32 v207, v82, v83
    s_add_u32 s34, s75, s77
    s_add_u32 s34, s34, 2048
    buffer_store_dwordx4 v[204:207], v184, s[56:59], s34 offen sc1
    v_pk_mul_f32 v[194:195], v[84:85], v[84:85]
    v_pk_mul_f32 v[196:197], v[86:87], v[86:87]
    v_pk_mul_f32 v[198:199], v[92:93], v[92:93]
    v_pk_mul_f32 v[200:201], v[94:95], v[94:95]
    v_pk_fma_f32 v[194:195], v[194:195], v[180:181], v[178:179]
    v_pk_fma_f32 v[196:197], v[196:197], v[180:181], v[178:179]
    v_pk_fma_f32 v[198:199], v[198:199], v[180:181], v[178:179]
    v_pk_fma_f32 v[200:201], v[200:201], v[180:181], v[178:179]
    v_pk_mul_f32 v[194:195], v[194:195], v[84:85]
    v_pk_mul_f32 v[196:197], v[196:197], v[86:87]
    v_pk_mul_f32 v[198:199], v[198:199], v[92:93]
    v_pk_mul_f32 v[200:201], v[200:201], v[94:95]
    v_exp_f32 v194, v194
    v_exp_f32 v195, v195
    v_exp_f32 v196, v196
    v_exp_f32 v197, v197
    v_exp_f32 v198, v198
    v_exp_f32 v199, v199
    v_exp_f32 v200, v200
    v_exp_f32 v201, v201
    v_pk_mul_f32 v[88:89], v[88:89], v[84:85]
    v_pk_mul_f32 v[90:91], v[90:91], v[86:87]
    v_pk_mul_f32 v[96:97], v[96:97], v[92:93]
    v_pk_mul_f32 v[98:99], v[98:99], v[94:95]
    v_pk_add_f32 v[194:195], v[194:195], v[182:183]
    v_pk_add_f32 v[196:197], v[196:197], v[182:183]
    v_pk_add_f32 v[198:199], v[198:199], v[182:183]
    v_pk_add_f32 v[200:201], v[200:201], v[182:183]
    v_rcp_f32 v194, v194
    v_rcp_f32 v195, v195
    v_rcp_f32 v196, v196
    v_rcp_f32 v197, v197
    v_rcp_f32 v198, v198
    v_rcp_f32 v199, v199
    v_rcp_f32 v200, v200
    v_rcp_f32 v201, v201
    s_nop 0
    v_pk_mul_f32 v[88:89], v[88:89], v[194:195]
    v_pk_mul_f32 v[90:91], v[90:91], v[196:197]
    v_pk_mul_f32 v[96:97], v[96:97], v[198:199]
    v_pk_mul_f32 v[98:99], v[98:99], v[200:201]
    v_cvt_pk_bf16_f32 v208, v88, v89
    v_cvt_pk_bf16_f32 v209, v90, v91
    v_cvt_pk_bf16_f32 v210, v96, v97
    v_cvt_pk_bf16_f32 v211, v98, v99
    s_add_u32 s34, s76, s77
    s_add_u32 s34, s34, 2048
    buffer_store_dwordx4 v[208:211], v184, s[56:59], s34 offen sc1
    v_pk_mul_f32 v[186:187], v[100:101], v[100:101]
    v_pk_mul_f32 v[188:189], v[102:103], v[102:103]
    v_pk_mul_f32 v[190:191], v[108:109], v[108:109]
    v_pk_mul_f32 v[192:193], v[110:111], v[110:111]
    v_pk_fma_f32 v[186:187], v[186:187], v[180:181], v[178:179]
    v_pk_fma_f32 v[188:189], v[188:189], v[180:181], v[178:179]
    v_pk_fma_f32 v[190:191], v[190:191], v[180:181], v[178:179]
    v_pk_fma_f32 v[192:193], v[192:193], v[180:181], v[178:179]
    v_pk_mul_f32 v[186:187], v[186:187], v[100:101]
    v_pk_mul_f32 v[188:189], v[188:189], v[102:103]
    v_pk_mul_f32 v[190:191], v[190:191], v[108:109]
    v_pk_mul_f32 v[192:193], v[192:193], v[110:111]
    v_exp_f32 v186, v186
    v_exp_f32 v187, v187
    v_exp_f32 v188, v188
    v_exp_f32 v189, v189
    v_exp_f32 v190, v190
    v_exp_f32 v191, v191
    v_exp_f32 v192, v192
    v_exp_f32 v193, v193
    v_pk_mul_f32 v[104:105], v[104:105], v[100:101]
    v_pk_mul_f32 v[106:107], v[106:107], v[102:103]
    v_pk_mul_f32 v[112:113], v[112:113], v[108:109]
    v_pk_mul_f32 v[114:115], v[114:115], v[110:111]
    v_pk_add_f32 v[186:187], v[186:187], v[182:183]
    v_pk_add_f32 v[188:189], v[188:189], v[182:183]
    v_pk_add_f32 v[190:191], v[190:191], v[182:183]
    v_pk_add_f32 v[192:193], v[192:193], v[182:183]
    v_rcp_f32 v186, v186
    v_rcp_f32 v187, v187
    v_rcp_f32 v188, v188
    v_rcp_f32 v189, v189
    v_rcp_f32 v190, v190
    v_rcp_f32 v191, v191
    v_rcp_f32 v192, v192
    v_rcp_f32 v193, v193
    s_nop 0
    v_pk_mul_f32 v[104:105], v[104:105], v[186:187]
    v_pk_mul_f32 v[106:107], v[106:107], v[188:189]
    v_pk_mul_f32 v[112:113], v[112:113], v[190:191]
    v_pk_mul_f32 v[114:115], v[114:115], v[192:193]
    v_cvt_pk_bf16_f32 v204, v104, v105
    v_cvt_pk_bf16_f32 v205, v106, v107
    v_cvt_pk_bf16_f32 v206, v112, v113
    v_cvt_pk_bf16_f32 v207, v114, v115
    s_add_u32 s34, s75, 3072
    buffer_store_dwordx4 v[204:207], v184, s[56:59], s34 offen sc1
    s_and_b32 s70, s2, 7
    s_lshl_b32 s70, s70, 5
    s_lshr_b32 s34, s2, 3
    s_add_u32 s70, s70, s34
    s_lshr_b32 s34, s33, 1
    s_lshl_b32 s68, s70, 1
    s_add_u32 s68, s68, s34
    s_mul_i32 s69, s34, 25792
    s_add_u32 s69, s69, 90624
    s_and_b32 s34, s33, 1
    s_lshl_b32 s34, s34, 8
    s_add_u32 s34, s34, s69
    v_and_b32 v2, 3, v0
    v_mul_u32_u24 v4, 4160, v2
    v_bfe_u32 v2, v0, 2, 2
    v_lshrrev_b32 v3, 4, v0
    v_add_u32 v2, v2, v3
    v_lshl_add_u32 v4, v2, 4, v4
    v_add_u32 v4, s34, v4
    v_and_b32 v2, 1, v0
    v_mul_u32_u24 v2, 4576, v2
    v_sub_u32 v5, 21664, v2
    v_bfe_u32 v2, v0, 1, 3
    v_lshlrev_b32 v2, 6, v2
    v_sub_u32 v5, v5, v2
    v_lshl_add_u32 v5, v3, 4, v5
    v_add_u32 v5, s34, v5
    v_mov_b32 v8, 0
    v_mov_b32 v9, 0
    v_mov_b32 v10, 0
    v_mov_b32 v11, 0
    v_mov_b32 v12, 0
    v_mov_b32 v13, 0
    v_mov_b32 v14, 0
    v_mov_b32 v15, 0
    v_mov_b32 v16, 0
    v_mov_b32 v17, 0
    v_mov_b32 v18, 0
    v_mov_b32 v19, 0
    v_mov_b32 v20, 0
    v_mov_b32 v21, 0
    v_mov_b32 v22, 0
    v_mov_b32 v23, 0
    v_mov_b32 v24, 0
    v_mov_b32 v25, 0
    v_mov_b32 v26, 0
    v_mov_b32 v27, 0
    v_mov_b32 v28, 0
    v_mov_b32 v29, 0
    v_mov_b32 v30, 0
    v_mov_b32 v31, 0
    v_mov_b32 v32, 0
    v_mov_b32 v33, 0
    v_mov_b32 v34, 0
    v_mov_b32 v35, 0
    v_mov_b32 v36, 0
    v_mov_b32 v37, 0
    v_mov_b32 v38, 0
    v_mov_b32 v39, 0
    s_barrier
    ds_read_b128 v[136:139], v5 offset:3584
    ds_read_b128 v[44:47], v4 offset:0
    ds_read_b128 v[132:135], v5 offset:3072
    ds_read_b128 v[48:51], v4 offset:512
    ds_read_b128 v[128:131], v5 offset:2560
    ds_read_b128 v[52:55], v4 offset:1024
    ds_read_b128 v[124:127], v5 offset:2048
    ds_read_b128 v[56:59], v4 offset:1536
    ds_read_b128 v[120:123], v5 offset:1536
    ds_read_b128 v[60:63], v4 offset:2048
    ds_read_b128 v[116:119], v5 offset:1024
    ds_read_b128 v[64:67], v4 offset:2560
    ds_read_b128 v[112:115], v5 offset:512
    ds_read_b128 v[68:71], v4 offset:3072
    ds_read_b128 v[108:111], v5 offset:0
    ds_read_b128 v[72:75], v4 offset:3584
    s_waitcnt vmcnt(7)
    v_and_b32 v2, 15, v0
    v_lshl_add_u32 v2, v3, 2, v2
    s_and_b32 s35, s33, 1
    s_cmp_eq_u32 s35, 0
    s_cselect_b32 s35, 15, 99
    v_add_u32 v3, 0, v2
    v_cmp_eq_u32 vcc, s35, v3
    s_nop 1
    v_cndmask_b32 v40, 0, v249, vcc
    v_add_u32 v3, 1, v2
    v_cmp_eq_u32 vcc, s35, v3
    s_nop 1
    v_cndmask_b32 v41, 0, v249, vcc
    v_add_u32 v3, 2, v2
    v_cmp_eq_u32 vcc, s35, v3
    s_nop 1
    v_cndmask_b32 v42, 0, v249, vcc
    v_add_u32 v3, 3, v2
    v_cmp_eq_u32 vcc, s35, v3
    s_nop 1
    v_cndmask_b32 v43, 0, v249, vcc
    s_waitcnt lgkmcnt(0)
    v_mfma_f32_16x16x32_bf16 v[8:11], v[136:139], v[44:47], v[8:11]
    v_mfma_f32_16x16x32_bf16 v[12:15], v[132:135], v[44:47], v[12:15]
    ds_read_b128 v[168:171], v5 offset:3648
    v_mfma_f32_16x16x32_bf16 v[16:19], v[128:131], v[44:47], v[16:19]
    v_mfma_f32_16x16x32_bf16 v[20:23], v[124:127], v[44:47], v[20:23]
    ds_read_b128 v[76:79], v4 offset:64
    v_mfma_f32_16x16x32_bf16 v[24:27], v[120:123], v[44:47], v[24:27]
    v_mfma_f32_16x16x32_bf16 v[28:31], v[116:119], v[44:47], v[28:31]
    ds_read_b128 v[164:167], v5 offset:3136
    v_mfma_f32_16x16x32_bf16 v[32:35], v[112:115], v[44:47], v[32:35]
    v_mfma_f32_16x16x32_bf16 v[36:39], v[108:111], v[44:47], v[36:39]
    ds_read_b128 v[80:83], v4 offset:576
    v_mfma_f32_16x16x32_bf16 v[12:15], v[136:139], v[48:51], v[12:15]
    v_mfma_f32_16x16x32_bf16 v[16:19], v[132:135], v[48:51], v[16:19]
    ds_read_b128 v[160:163], v5 offset:2624
    v_mfma_f32_16x16x32_bf16 v[20:23], v[128:131], v[48:51], v[20:23]
    v_mfma_f32_16x16x32_bf16 v[24:27], v[124:127], v[48:51], v[24:27]
    ds_read_b128 v[84:87], v4 offset:1088
    v_mfma_f32_16x16x32_bf16 v[28:31], v[120:123], v[48:51], v[28:31]
    v_mfma_f32_16x16x32_bf16 v[32:35], v[116:119], v[48:51], v[32:35]
    ds_read_b128 v[156:159], v5 offset:2112
    v_mfma_f32_16x16x32_bf16 v[36:39], v[112:115], v[48:51], v[36:39]
    v_mfma_f32_16x16x32_bf16 v[16:19], v[136:139], v[52:55], v[16:19]
    ds_read_b128 v[88:91], v4 offset:1600
    v_mfma_f32_16x16x32_bf16 v[20:23], v[132:135], v[52:55], v[20:23]
    v_mfma_f32_16x16x32_bf16 v[24:27], v[128:131], v[52:55], v[24:27]
    ds_read_b128 v[152:155], v5 offset:1600
    v_mfma_f32_16x16x32_bf16 v[28:31], v[124:127], v[52:55], v[28:31]
    v_mfma_f32_16x16x32_bf16 v[32:35], v[120:123], v[52:55], v[32:35]
    ds_read_b128 v[92:95], v4 offset:2112
    v_mfma_f32_16x16x32_bf16 v[36:39], v[116:119], v[52:55], v[36:39]
    v_mfma_f32_16x16x32_bf16 v[20:23], v[136:139], v[56:59], v[20:23]
    ds_read_b128 v[148:151], v5 offset:1088
    v_mfma_f32_16x16x32_bf16 v[24:27], v[132:135], v[56:59], v[24:27]
    v_mfma_f32_16x16x32_bf16 v[28:31], v[128:131], v[56:59], v[28:31]
    ds_read_b128 v[96:99], v4 offset:2624
    v_mfma_f32_16x16x32_bf16 v[32:35], v[124:127], v[56:59], v[32:35]
    v_mfma_f32_16x16x32_bf16 v[36:39], v[120:123], v[56:59], v[36:39]
    ds_read_b128 v[144:147], v5 offset:576
    v_mfma_f32_16x16x32_bf16 v[24:27], v[136:139], v[60:63], v[24:27]
    v_mfma_f32_16x16x32_bf16 v[28:31], v[132:135], v[60:63], v[28:31]
    ds_read_b128 v[100:103], v4 offset:3136
    v_mfma_f32_16x16x32_bf16 v[32:35], v[128:131], v[60:63], v[32:35]
    v_mfma_f32_16x16x32_bf16 v[36:39], v[124:127], v[60:63], v[36:39]
    ds_read_b128 v[140:143], v5 offset:64
    v_mfma_f32_16x16x32_bf16 v[28:31], v[136:139], v[64:67], v[28:31]
    v_mfma_f32_16x16x32_bf16 v[32:35], v[132:135], v[64:67], v[32:35]
    ds_read_b128 v[104:107], v4 offset:3648
    v_mfma_f32_16x16x32_bf16 v[36:39], v[128:131], v[64:67], v[36:39]
    v_mfma_f32_16x16x32_bf16 v[32:35], v[136:139], v[68:71], v[32:35]
    v_mfma_f32_16x16x32_bf16 v[36:39], v[132:135], v[68:71], v[36:39]
    v_mfma_f32_16x16x32_bf16 v[36:39], v[136:139], v[72:75], v[36:39]
    v_mfma_f32_16x16x32_bf16 v[8:11], v[136:139], v[40:43], v[8:11]
    v_mfma_f32_16x16x32_bf16 v[12:15], v[132:135], v[40:43], v[12:15]
    v_mfma_f32_16x16x32_bf16 v[16:19], v[128:131], v[40:43], v[16:19]
    v_mfma_f32_16x16x32_bf16 v[20:23], v[124:127], v[40:43], v[20:23]
    v_mfma_f32_16x16x32_bf16 v[24:27], v[120:123], v[40:43], v[24:27]
    v_mfma_f32_16x16x32_bf16 v[28:31], v[116:119], v[40:43], v[28:31]
    v_mfma_f32_16x16x32_bf16 v[32:35], v[112:115], v[40:43], v[32:35]
    v_mfma_f32_16x16x32_bf16 v[36:39], v[108:111], v[40:43], v[36:39]
    s_waitcnt lgkmcnt(0)
    v_mfma_f32_16x16x32_bf16 v[8:11], v[168:171], v[76:79], v[8:11]
    v_mfma_f32_16x16x32_bf16 v[12:15], v[164:167], v[76:79], v[12:15]
    ds_read_b128 v[136:139], v5 offset:3712
    v_mfma_f32_16x16x32_bf16 v[16:19], v[160:163], v[76:79], v[16:19]
    v_mfma_f32_16x16x32_bf16 v[20:23], v[156:159], v[76:79], v[20:23]
    ds_read_b128 v[44:47], v4 offset:128
    v_mfma_f32_16x16x32_bf16 v[24:27], v[152:155], v[76:79], v[24:27]
    v_mfma_f32_16x16x32_bf16 v[28:31], v[148:151], v[76:79], v[28:31]
    ds_read_b128 v[132:135], v5 offset:3200
    v_mfma_f32_16x16x32_bf16 v[32:35], v[144:147], v[76:79], v[32:35]
    v_mfma_f32_16x16x32_bf16 v[36:39], v[140:143], v[76:79], v[36:39]
    ds_read_b128 v[48:51], v4 offset:640
    v_mfma_f32_16x16x32_bf16 v[12:15], v[168:171], v[80:83], v[12:15]
    v_mfma_f32_16x16x32_bf16 v[16:19], v[164:167], v[80:83], v[16:19]
    ds_read_b128 v[128:131], v5 offset:2688
    v_mfma_f32_16x16x32_bf16 v[20:23], v[160:163], v[80:83], v[20:23]
    v_mfma_f32_16x16x32_bf16 v[24:27], v[156:159], v[80:83], v[24:27]
    ds_read_b128 v[52:55], v4 offset:1152
    v_mfma_f32_16x16x32_bf16 v[28:31], v[152:155], v[80:83], v[28:31]
    v_mfma_f32_16x16x32_bf16 v[32:35], v[148:151], v[80:83], v[32:35]
    ds_read_b128 v[124:127], v5 offset:2176
    v_mfma_f32_16x16x32_bf16 v[36:39], v[144:147], v[80:83], v[36:39]
    v_mfma_f32_16x16x32_bf16 v[16:19], v[168:171], v[84:87], v[16:19]
    ds_read_b128 v[56:59], v4 offset:1664
    v_mfma_f32_16x16x32_bf16 v[20:23], v[164:167], v[84:87], v[20:23]
    v_mfma_f32_16x16x32_bf16 v[24:27], v[160:163], v[84:87], v[24:27]
    ds_read_b128 v[120:123], v5 offset:1664
    v_mfma_f32_16x16x32_bf16 v[28:31], v[156:159], v[84:87], v[28:31]
    v_mfma_f32_16x16x32_bf16 v[32:35], v[152:155], v[84:87], v[32:35]
    ds_read_b128 v[60:63], v4 offset:2176
    v_mfma_f32_16x16x32_bf16 v[36:39], v[148:151], v[84:87], v[36:39]
    v_mfma_f32_16x16x32_bf16 v[20:23], v[168:171], v[88:91], v[20:23]
    ds_read_b128 v[116:119], v5 offset:1152
    v_mfma_f32_16x16x32_bf16 v[24:27], v[164:167], v[88:91], v[24:27]
    v_mfma_f32_16x16x32_bf16 v[28:31], v[160:163], v[88:91], v[28:31]
    ds_read_b128 v[64:67], v4 offset:2688
    v_mfma_f32_16x16x32_bf16 v[32:35], v[156:159], v[88:91], v[32:35]
    v_mfma_f32_16x16x32_bf16 v[36:39], v[152:155], v[88:91], v[36:39]
    ds_read_b128 v[112:115], v5 offset:640
    v_mfma_f32_16x16x32_bf16 v[24:27], v[168:171], v[92:95], v[24:27]
    v_mfma_f32_16x16x32_bf16 v[28:31], v[164:167], v[92:95], v[28:31]
    ds_read_b128 v[68:71], v4 offset:3200
    v_mfma_f32_16x16x32_bf16 v[32:35], v[160:163], v[92:95], v[32:35]
    v_mfma_f32_16x16x32_bf16 v[36:39], v[156:159], v[92:95], v[36:39]
    ds_read_b128 v[108:111], v5 offset:128
    v_mfma_f32_16x16x32_bf16 v[28:31], v[168:171], v[96:99], v[28:31]
    v_mfma_f32_16x16x32_bf16 v[32:35], v[164:167], v[96:99], v[32:35]
    ds_read_b128 v[72:75], v4 offset:3712
    v_mfma_f32_16x16x32_bf16 v[36:39], v[160:163], v[96:99], v[36:39]
    v_mfma_f32_16x16x32_bf16 v[32:35], v[168:171], v[100:103], v[32:35]
    v_mfma_f32_16x16x32_bf16 v[36:39], v[164:167], v[100:103], v[36:39]
    v_mfma_f32_16x16x32_bf16 v[36:39], v[168:171], v[104:107], v[36:39]
    s_waitcnt lgkmcnt(0)
    v_mfma_f32_16x16x32_bf16 v[8:11], v[136:139], v[44:47], v[8:11]
    v_mfma_f32_16x16x32_bf16 v[12:15], v[132:135], v[44:47], v[12:15]
    ds_read_b128 v[168:171], v5 offset:3776
    v_mfma_f32_16x16x32_bf16 v[16:19], v[128:131], v[44:47], v[16:19]
    v_mfma_f32_16x16x32_bf16 v[20:23], v[124:127], v[44:47], v[20:23]
    ds_read_b128 v[76:79], v4 offset:192
    v_mfma_f32_16x16x32_bf16 v[24:27], v[120:123], v[44:47], v[24:27]
    v_mfma_f32_16x16x32_bf16 v[28:31], v[116:119], v[44:47], v[28:31]
    ds_read_b128 v[164:167], v5 offset:3264
    v_mfma_f32_16x16x32_bf16 v[32:35], v[112:115], v[44:47], v[32:35]
    v_mfma_f32_16x16x32_bf16 v[36:39], v[108:111], v[44:47], v[36:39]
    ds_read_b128 v[80:83], v4 offset:704
    v_mfma_f32_16x16x32_bf16 v[12:15], v[136:139], v[48:51], v[12:15]
    v_mfma_f32_16x16x32_bf16 v[16:19], v[132:135], v[48:51], v[16:19]
    ds_read_b128 v[160:163], v5 offset:2752
    v_mfma_f32_16x16x32_bf16 v[20:23], v[128:131], v[48:51], v[20:23]
    v_mfma_f32_16x16x32_bf16 v[24:27], v[124:127], v[48:51], v[24:27]
    ds_read_b128 v[84:87], v4 offset:1216
    v_mfma_f32_16x16x32_bf16 v[28:31], v[120:123], v[48:51], v[28:31]
    v_mfma_f32_16x16x32_bf16 v[32:35], v[116:119], v[48:51], v[32:35]
    ds_read_b128 v[156:159], v5 offset:2240
    v_mfma_f32_16x16x32_bf16 v[36:39], v[112:115], v[48:51], v[36:39]
    v_mfma_f32_16x16x32_bf16 v[16:19], v[136:139], v[52:55], v[16:19]
    ds_read_b128 v[88:91], v4 offset:1728
    v_mfma_f32_16x16x32_bf16 v[20:23], v[132:135], v[52:55], v[20:23]
    v_mfma_f32_16x16x32_bf16 v[24:27], v[128:131], v[52:55], v[24:27]
    ds_read_b128 v[152:155], v5 offset:1728
    v_mfma_f32_16x16x32_bf16 v[28:31], v[124:127], v[52:55], v[28:31]
    v_mfma_f32_16x16x32_bf16 v[32:35], v[120:123], v[52:55], v[32:35]
    ds_read_b128 v[92:95], v4 offset:2240
    v_mfma_f32_16x16x32_bf16 v[36:39], v[116:119], v[52:55], v[36:39]
    v_mfma_f32_16x16x32_bf16 v[20:23], v[136:139], v[56:59], v[20:23]
    ds_read_b128 v[148:151], v5 offset:1216
    v_mfma_f32_16x16x32_bf16 v[24:27], v[132:135], v[56:59], v[24:27]
    v_mfma_f32_16x16x32_bf16 v[28:31], v[128:131], v[56:59], v[28:31]
    ds_read_b128 v[96:99], v4 offset:2752
    v_mfma_f32_16x16x32_bf16 v[32:35], v[124:127], v[56:59], v[32:35]
    v_mfma_f32_16x16x32_bf16 v[36:39], v[120:123], v[56:59], v[36:39]
    ds_read_b128 v[144:147], v5 offset:704
    v_mfma_f32_16x16x32_bf16 v[24:27], v[136:139], v[60:63], v[24:27]
    v_mfma_f32_16x16x32_bf16 v[28:31], v[132:135], v[60:63], v[28:31]
    ds_read_b128 v[100:103], v4 offset:3264
    v_mfma_f32_16x16x32_bf16 v[32:35], v[128:131], v[60:63], v[32:35]
    v_mfma_f32_16x16x32_bf16 v[36:39], v[124:127], v[60:63], v[36:39]
    ds_read_b128 v[140:143], v5 offset:192
    v_mfma_f32_16x16x32_bf16 v[28:31], v[136:139], v[64:67], v[28:31]
    v_mfma_f32_16x16x32_bf16 v[32:35], v[132:135], v[64:67], v[32:35]
    ds_read_b128 v[104:107], v4 offset:3776
    v_mfma_f32_16x16x32_bf16 v[36:39], v[128:131], v[64:67], v[36:39]
    v_mfma_f32_16x16x32_bf16 v[32:35], v[136:139], v[68:71], v[32:35]
    v_mfma_f32_16x16x32_bf16 v[36:39], v[132:135], v[68:71], v[36:39]
    v_mfma_f32_16x16x32_bf16 v[36:39], v[136:139], v[72:75], v[36:39]
    s_waitcnt vmcnt(0) lgkmcnt(0)
    s_barrier
    s_waitcnt lgkmcnt(0)
    v_mfma_f32_16x16x32_bf16 v[8:11], v[168:171], v[76:79], v[8:11]
    v_mfma_f32_16x16x32_bf16 v[12:15], v[164:167], v[76:79], v[12:15]
    v_mfma_f32_16x16x32_bf16 v[16:19], v[160:163], v[76:79], v[16:19]
    v_mfma_f32_16x16x32_bf16 v[20:23], v[156:159], v[76:79], v[20:23]
    v_mfma_f32_16x16x32_bf16 v[24:27], v[152:155], v[76:79], v[24:27]
    v_mfma_f32_16x16x32_bf16 v[28:31], v[148:151], v[76:79], v[28:31]
    v_mfma_f32_16x16x32_bf16 v[32:35], v[144:147], v[76:79], v[32:35]
    v_mfma_f32_16x16x32_bf16 v[36:39], v[140:143], v[76:79], v[36:39]
    v_mfma_f32_16x16x32_bf16 v[12:15], v[168:171], v[80:83], v[12:15]
    v_mfma_f32_16x16x32_bf16 v[16:19], v[164:167], v[80:83], v[16:19]
    v_mfma_f32_16x16x32_bf16 v[20:23], v[160:163], v[80:83], v[20:23]
    v_mfma_f32_16x16x32_bf16 v[24:27], v[156:159], v[80:83], v[24:27]
    v_mfma_f32_16x16x32_bf16 v[28:31], v[152:155], v[80:83], v[28:31]
    v_mfma_f32_16x16x32_bf16 v[32:35], v[148:151], v[80:83], v[32:35]
    v_mfma_f32_16x16x32_bf16 v[36:39], v[144:147], v[80:83], v[36:39]
    v_mfma_f32_16x16x32_bf16 v[16:19], v[168:171], v[84:87], v[16:19]
    v_mfma_f32_16x16x32_bf16 v[20:23], v[164:167], v[84:87], v[20:23]
    v_mfma_f32_16x16x32_bf16 v[24:27], v[160:163], v[84:87], v[24:27]
    v_mfma_f32_16x16x32_bf16 v[28:31], v[156:159], v[84:87], v[28:31]
    v_mfma_f32_16x16x32_bf16 v[32:35], v[152:155], v[84:87], v[32:35]
    v_mfma_f32_16x16x32_bf16 v[36:39], v[148:151], v[84:87], v[36:39]
    v_mfma_f32_16x16x32_bf16 v[20:23], v[168:171], v[88:91], v[20:23]
    v_mfma_f32_16x16x32_bf16 v[24:27], v[164:167], v[88:91], v[24:27]
    v_mfma_f32_16x16x32_bf16 v[28:31], v[160:163], v[88:91], v[28:31]
    v_mfma_f32_16x16x32_bf16 v[32:35], v[156:159], v[88:91], v[32:35]
    v_mfma_f32_16x16x32_bf16 v[36:39], v[152:155], v[88:91], v[36:39]
    v_mfma_f32_16x16x32_bf16 v[24:27], v[168:171], v[92:95], v[24:27]
    v_mfma_f32_16x16x32_bf16 v[28:31], v[164:167], v[92:95], v[28:31]
    v_mfma_f32_16x16x32_bf16 v[32:35], v[160:163], v[92:95], v[32:35]
    v_mfma_f32_16x16x32_bf16 v[36:39], v[156:159], v[92:95], v[36:39]
    v_mfma_f32_16x16x32_bf16 v[28:31], v[168:171], v[96:99], v[28:31]
    v_mfma_f32_16x16x32_bf16 v[32:35], v[164:167], v[96:99], v[32:35]
    v_mfma_f32_16x16x32_bf16 v[36:39], v[160:163], v[96:99], v[36:39]
    v_mfma_f32_16x16x32_bf16 v[32:35], v[168:171], v[100:103], v[32:35]
    v_mfma_f32_16x16x32_bf16 v[36:39], v[164:167], v[100:103], v[36:39]
    v_mfma_f32_16x16x32_bf16 v[36:39], v[168:171], v[104:107], v[36:39]
    s_nop 7
    s_lshl_b32 s34, s33, 13
    s_add_u32 s34, s34, 90624
    v_lshrrev_b32 v2, 4, v0
    v_lshlrev_b32 v2, 8, v2
    v_and_b32 v3, 15, v0
    v_lshl_add_u32 v2, v3, 3, v2
    v_add_u32 v2, s34, v2
    ds_write_b64 v2, v[8:9] offset:0
    ds_write_b64 v2, v[10:11] offset:128
    ds_write_b64 v2, v[12:13] offset:1024
    ds_write_b64 v2, v[14:15] offset:1152
    ds_write_b64 v2, v[16:17] offset:2048
    ds_write_b64 v2, v[18:19] offset:2176
    ds_write_b64 v2, v[20:21] offset:3072
    ds_write_b64 v2, v[22:23] offset:3200
    ds_write_b64 v2, v[24:25] offset:4096
    ds_write_b64 v2, v[26:27] offset:4224
    ds_write_b64 v2, v[28:29] offset:5120
    ds_write_b64 v2, v[30:31] offset:5248
    ds_write_b64 v2, v[32:33] offset:6144
    ds_write_b64 v2, v[34:35] offset:6272
    ds_write_b64 v2, v[36:37] offset:7168
    ds_write_b64 v2, v[38:39] offset:7296
    s_waitcnt lgkmcnt(0)
    s_barrier
    s_and_b32 s34, s2, 7
    s_lshr_b32 s35, s2, 3
    s_lshl_b32 s71, s34, 2
    s_and_b32 s36, s35, 3
    s_add_u32 s71, s71, s36
    s_lshr_b32 s72, s35, 2
    s_mul_i32 s73, s72, 3
    s_and_b32 s34, s71, 3
    s_mul_i32 s34, s34, 7
    s_add_u32 s73, s73, s34
    s_cmp_ge_u32 s73, 28
    s_cselect_b32 s34, 28, 0
    s_sub_u32 s73, s73, s34
    s_mov_b32 s52, s22
    s_mov_b32 s53, s23
    s_mov_b32 s54, 1835008
    s_mov_b32 s55, 0x20000
    v_lshrrev_b32 v145, 3, v0
    v_bfe_u32 v146, v0, 4, 1
    v_lshlrev_b32 v146, 2, v146
    v_and_b32 v141, 7, v0
    v_xor_b32 v141, v141, v146
    v_lshlrev_b32 v141, 4, v141
    v_lshl_add_u32 v141, v145, 10, v141
    s_lshl_b32 s34, s72, 7
    v_add_u32 v141, s34, v141
    v_add_u32 v142, 7168, v141
    s_mul_i32 s75, s33, 458752
    s_mul_i32 s76, s33, 22528
    s_add_u32 s78, s73, 7
    s_cmp_ge_u32 s78, 28
    s_cselect_b32 s34, 28, 0
    s_sub_u32 s78, s78, s34
    s_lshl_b32 s80, s78, 14
    s_add_u32 m0, s76, 14336
    s_add_u32 s80, s80, s75
    buffer_load_dwordx4 v141, s[52:55], s80 offen lds
    buffer_load_dwordx4 v142, s[52:55], s80 offen offset:1024 lds
    s_add_u32 s78, s78, 1
    s_cmp_eq_u32 s78, 28
    s_cselect_b32 s78, 0, s78
    s_lshl_b32 s80, s78, 14
    s_add_u32 m0, s76, 16384
    s_add_u32 s80, s80, s75
    buffer_load_dwordx4 v141, s[52:55], s80 offen lds
    buffer_load_dwordx4 v142, s[52:55], s80 offen offset:1024 lds
    s_add_u32 s78, s78, 1
    s_cmp_eq_u32 s78, 28
    s_cselect_b32 s78, 0, s78
    s_lshl_b32 s80, s78, 14
    s_add_u32 m0, s76, 18432
    s_add_u32 s80, s80, s75
    buffer_load_dwordx4 v141, s[52:55], s80 offen lds
    buffer_load_dwordx4 v142, s[52:55], s80 offen offset:1024 lds
    s_add_u32 s78, s78, 1
    s_cmp_eq_u32 s78, 28
    s_cselect_b32 s78, 0, s78
    s_lshl_b32 s80, s78, 14
    s_add_u32 m0, s76, 20480
    s_add_u32 s80, s80, s75
    buffer_load_dwordx4 v141, s[52:55], s80 offen lds
    buffer_load_dwordx4 v142, s[52:55], s80 offen offset:1024 lds
    s_add_u32 s78, s78, 1
    s_cmp_eq_u32 s78, 28
    s_cselect_b32 s78, 0, s78
    s_add_u32 s56, s30, 10485760
    s_addc_u32 s57, s31, 0
    s_mov_b32 s58, 2097152
    s_mov_b32 s59, 0x20000
    s_lshr_b32 s34, s33, 1
    s_lshl_b32 s34, s34, 14
    s_and_b32 s35, s33, 1
    s_lshl_b32 s36, s35, 11
    s_add_u32 s34, s34, s36
    s_add_u32 s34, s34, 90624
    v_lshlrev_b32 v68, 5, v0
    v_add_u32 v68, s34, v68
    ds_read_b128 v[72:75], v68 offset:0
    ds_read_b128 v[76:79], v68 offset:16
    ds_read_b128 v[80:83], v68 offset:8192
    ds_read_b128 v[84:87], v68 offset:8208
    ds_read_b128 v[88:91], v68 offset:4096
    ds_read_b128 v[92:95], v68 offset:4112
    ds_read_b128 v[96:99], v68 offset:12288
    ds_read_b128 v[100:103], v68 offset:12304
    s_lshl_b32 s34, s68, 12
    s_lshl_b32 s35, s35, 10
    s_add_u32 s34, s34, s35
    v_lshlrev_b32 v69, 4, v0
    s_waitcnt lgkmcnt(4)
    v_add_f32 v72, v72, v80
    v_add_f32 v76, v76, v84
    v_add_f32 v73, v73, v81
    v_add_f32 v77, v77, v85
    v_add_f32 v74, v74, v82
    v_add_f32 v78, v78, v86
    v_add_f32 v75, v75, v83
    v_add_f32 v79, v79, v87
    v_cvt_pk_bf16_f32 v104, v72, v73
    v_cvt_pk_bf16_f32 v105, v74, v75
    v_cvt_pk_bf16_f32 v106, v76, v77
    v_cvt_pk_bf16_f32 v107, v78, v79
    buffer_store_dwordx4 v[104:107], v69, s[56:59], s34 offen offset:0 sc1
    s_waitcnt lgkmcnt(0)
    v_add_f32 v88, v88, v96
    v_add_f32 v92, v92, v100
    v_add_f32 v89, v89, v97
    v_add_f32 v93, v93, v101
    v_add_f32 v90, v90, v98
    v_add_f32 v94, v94, v102
    v_add_f32 v91, v91, v99
    v_add_f32 v95, v95, v103
    v_cvt_pk_bf16_f32 v108, v88, v89
    v_cvt_pk_bf16_f32 v109, v90, v91
    v_cvt_pk_bf16_f32 v110, v92, v93
    v_cvt_pk_bf16_f32 v111, v94, v95
    buffer_store_dwordx4 v[108:111], v69, s[56:59], s34 offen offset:2048 sc1
    s_add_u32 s48, s30, 3145728
    s_addc_u32 s49, s31, 0
    s_mov_b32 s50, 7340032
    s_mov_b32 s51, 0x20000
    s_mov_b32 s60, s4
    s_mov_b32 s61, s5
    s_mov_b32 s62, 2097152
    s_mov_b32 s63, 0x20000
    s_add_u32 s64, s30, 2097152
    s_addc_u32 s65, s31, 0
    s_mov_b32 s66, 8192
    s_mov_b32 s67, 0x20000
    s_and_b32 s34, s33, 1
    s_lshl_b32 s34, s34, 5
    s_lshl_b32 s35, s71, 6
    s_add_u32 s34, s34, s35
    v_and_b32 v145, 31, v0
    v_add_u32 v145, s34, v145
    v_lshlrev_b32 v157, 2, v145
    v_lshlrev_b32 v156, 10, v145
    v_lshrrev_b32 v146, 5, v0
    v_lshl_add_u32 v156, v146, 3, v156
    s_lshr_b32 s34, s33, 1
    s_lshl_b32 s34, s34, 6
    s_lshl_b32 s35, s72, 7
    s_add_u32 s34, s34, s35
    v_add_u32 v156, s34, v156
    v_lshl_add_u32 v156, v146, 3, v156
    buffer_load_dwordx4 v[148:151], v156, s[60:63], 0 offen offset:0
    buffer_load_dwordx4 v[152:155], v156, s[60:63], 0 offen offset:32
    v_lshlrev_b32 v140, 4, v0
    s_mul_i32 s74, s71, 224
    s_mul_i32 s34, s33, 28
    s_add_u32 s74, s74, s34
    s_lshl_b32 s74, s74, 10
    s_mov_b32 s77, s73
    v_lshrrev_b32 v145, 5, v0
    v_lshlrev_b32 v145, 2, v145
    v_bfe_u32 v146, v0, 2, 2
    v_add_u32 v145, v145, v146
    v_lshlrev_b32 v143, 7, v145
    v_bfe_u32 v145, v0, 4, 1
    v_lshlrev_b32 v145, 1, v145
    v_bfe_u32 v146, v0, 1, 1
    v_add_u32 v145, v145, v146
    v_bfe_u32 v146, v0, 3, 1
    v_lshlrev_b32 v146, 2, v146
    v_xor_b32 v145, v145, v146
    v_lshl_add_u32 v143, v145, 4, v143
    v_and_b32 v145, 1, v0
    v_lshl_add_u32 v143, v145, 3, v143
    v_add_u32 v143, s76, v143
    v_xor_b32 v144, 64, v143
    v_mov_b32 v4, 0
    v_mov_b32 v5, 0
    v_mov_b32 v6, 0
    v_mov_b32 v7, 0
    v_mov_b32 v8, 0
    v_mov_b32 v9, 0
    v_mov_b32 v10, 0
    v_mov_b32 v11, 0
    v_mov_b32 v12, 0
    v_mov_b32 v13, 0
    v_mov_b32 v14, 0
    v_mov_b32 v15, 0
    v_mov_b32 v16, 0
    v_mov_b32 v17, 0
    v_mov_b32 v18, 0
    v_mov_b32 v19, 0
    v_mov_b32 v20, 0
    v_mov_b32 v21, 0
    v_mov_b32 v22, 0
    v_mov_b32 v23, 0
    v_mov_b32 v24, 0
    v_mov_b32 v25, 0
    v_mov_b32 v26, 0
    v_mov_b32 v27, 0
    v_mov_b32 v28, 0
    v_mov_b32 v29, 0
    v_mov_b32 v30, 0
    v_mov_b32 v31, 0
    v_mov_b32 v32, 0
    v_mov_b32 v33, 0
    v_mov_b32 v34, 0
    v_mov_b32 v35, 0
    v_mov_b32 v36, 0
    v_mov_b32 v37, 0
    v_mov_b32 v38, 0
    v_mov_b32 v39, 0
    v_mov_b32 v40, 0
    v_mov_b32 v41, 0
    v_mov_b32 v42, 0
    v_mov_b32 v43, 0
    v_mov_b32 v44, 0
    v_mov_b32 v45, 0
    v_mov_b32 v46, 0
    v_mov_b32 v47, 0
    v_mov_b32 v48, 0
    v_mov_b32 v49, 0
    v_mov_b32 v50, 0
    v_mov_b32 v51, 0
    v_mov_b32 v52, 0
    v_mov_b32 v53, 0
    v_mov_b32 v54, 0
    v_mov_b32 v55, 0
    v_mov_b32 v56, 0
    v_mov_b32 v57, 0
    v_mov_b32 v58, 0
    v_mov_b32 v59, 0
    v_mov_b32 v60, 0
    v_mov_b32 v61, 0
    v_mov_b32 v62, 0
    v_mov_b32 v63, 0
    v_mov_b32 v64, 0
    v_mov_b32 v65, 0
    v_mov_b32 v66, 0
    v_mov_b32 v67, 0
    s_waitcnt vmcnt(4)
    ds_read_b64_tr_b16 v[160:161], v143 offset:14336
    ds_read_b64_tr_b16 v[162:163], v143 offset:15360
    ds_read_b64_tr_b16 v[164:165], v144 offset:14336
    ds_read_b64_tr_b16 v[166:167], v144 offset:15360
    ds_read_b64_tr_b16 v[168:169], v143 offset:16384
    ds_read_b64_tr_b16 v[170:171], v143 offset:17408
    ds_read_b64_tr_b16 v[172:173], v144 offset:16384
    ds_read_b64_tr_b16 v[174:175], v144 offset:17408
    ds_read_b64_tr_b16 v[176:177], v143 offset:18432
    ds_read_b64_tr_b16 v[178:179], v143 offset:19456
    ds_read_b64_tr_b16 v[180:181], v144 offset:18432
    ds_read_b64_tr_b16 v[182:183], v144 offset:19456
    ds_read_b64_tr_b16 v[184:185], v143 offset:20480
    ds_read_b64_tr_b16 v[186:187], v143 offset:21504
    ds_read_b64_tr_b16 v[188:189], v144 offset:20480
    ds_read_b64_tr_b16 v[190:191], v144 offset:21504
    s_waitcnt lgkmcnt(0)
    s_lshl_b32 s80, s78, 14
    s_add_u32 m0, s76, 14336
    s_add_u32 s80, s80, s75
    buffer_load_dwordx4 v141, s[52:55], s80 offen lds
    buffer_load_dwordx4 v142, s[52:55], s80 offen offset:1024 lds
    s_add_u32 s78, s78, 1
    s_cmp_eq_u32 s78, 28
    s_cselect_b32 s78, 0, s78
    s_lshl_b32 s80, s78, 14
    s_add_u32 m0, s76, 16384
    s_add_u32 s80, s80, s75
    buffer_load_dwordx4 v141, s[52:55], s80 offen lds
    buffer_load_dwordx4 v142, s[52:55], s80 offen offset:1024 lds
    s_add_u32 s78, s78, 1
    s_cmp_eq_u32 s78, 28
    s_cselect_b32 s78, 0, s78
    s_lshl_b32 s80, s78, 14
    s_add_u32 m0, s76, 18432
    s_add_u32 s80, s80, s75
    buffer_load_dwordx4 v141, s[52:55], s80 offen lds
    buffer_load_dwordx4 v142, s[52:55], s80 offen offset:1024 lds
    s_add_u32 s78, s78, 1
    s_cmp_eq_u32 s78, 28
    s_cselect_b32 s78, 0, s78
    s_lshl_b32 s80, s78, 14
    s_add_u32 m0, s76, 20480
    s_add_u32 s80, s80, s75
    buffer_load_dwordx4 v141, s[52:55], s80 offen lds
    buffer_load_dwordx4 v142, s[52:55], s80 offen offset:1024 lds
    s_add_u32 s78, s78, 1
    s_cmp_eq_u32 s78, 28
    s_cselect_b32 s78, 0, s78
    s_barrier
    s_lshl_b32 s79, s77, 10
    s_add_u32 s79, s79, s74
    s_add_u32 s34, s79, 114688
    buffer_load_dwordx4 v[68:71], v140, s[48:51], s79 offen sc1
    buffer_load_dwordx4 v[72:75], v140, s[48:51], s34 offen sc1
    s_add_u32 s77, s77, 1
    s_cmp_eq_u32 s77, 28
    s_cselect_b32 s77, 0, s77
    s_lshl_b32 s79, s77, 10
    s_add_u32 s79, s79, s74
    s_add_u32 s34, s79, 114688
    buffer_load_dwordx4 v[76:79], v140, s[48:51], s79 offen sc1
    buffer_load_dwordx4 v[80:83], v140, s[48:51], s34 offen sc1
    s_add_u32 s77, s77, 1
    s_cmp_eq_u32 s77, 28
    s_cselect_b32 s77, 0, s77
    s_lshl_b32 s79, s77, 10
    s_add_u32 s79, s79, s74
    s_add_u32 s34, s79, 114688
    buffer_load_dwordx4 v[84:87], v140, s[48:51], s79 offen sc1
    buffer_load_dwordx4 v[88:91], v140, s[48:51], s34 offen sc1
    s_add_u32 s77, s77, 1
    s_cmp_eq_u32 s77, 28
    s_cselect_b32 s77, 0, s77
    s_lshl_b32 s79, s77, 10
    s_add_u32 s79, s79, s74
    s_add_u32 s34, s79, 114688
    buffer_load_dwordx4 v[92:95], v140, s[48:51], s79 offen sc1
    buffer_load_dwordx4 v[96:99], v140, s[48:51], s34 offen sc1
    s_add_u32 s77, s77, 1
    s_cmp_eq_u32 s77, 28
    s_cselect_b32 s77, 0, s77
    s_lshl_b32 s79, s77, 10
    s_add_u32 s79, s79, s74
    s_add_u32 s34, s79, 114688
    buffer_load_dwordx4 v[100:103], v140, s[48:51], s79 offen sc1
    buffer_load_dwordx4 v[104:107], v140, s[48:51], s34 offen sc1
    s_add_u32 s77, s77, 1
    s_cmp_eq_u32 s77, 28
    s_cselect_b32 s77, 0, s77
    s_lshl_b32 s79, s77, 10
    s_add_u32 s79, s79, s74
    s_add_u32 s34, s79, 114688
    buffer_load_dwordx4 v[108:111], v140, s[48:51], s79 offen sc1
    buffer_load_dwordx4 v[112:115], v140, s[48:51], s34 offen sc1
    s_add_u32 s77, s77, 1
    s_cmp_eq_u32 s77, 28
    s_cselect_b32 s77, 0, s77
    s_lshl_b32 s79, s77, 10
    s_add_u32 s79, s79, s74
    s_add_u32 s34, s79, 114688
    buffer_load_dwordx4 v[116:119], v140, s[48:51], s79 offen sc1
    buffer_load_dwordx4 v[120:123], v140, s[48:51], s34 offen sc1
    s_add_u32 s77, s77, 1
    s_cmp_eq_u32 s77, 28
    s_cselect_b32 s77, 0, s77
    buffer_load_dword v157, v157, s[64:67], 0 offen sc1
    ds_read_b64_tr_b16 v[124:125], v143 offset:0
    ds_read_b64_tr_b16 v[126:127], v143 offset:1024
    ds_read_b64_tr_b16 v[128:129], v144 offset:0
    ds_read_b64_tr_b16 v[130:131], v144 offset:1024
    s_waitcnt vmcnt(13)
    ds_read_b64_tr_b16 v[132:133], v143 offset:2048
    ds_read_b64_tr_b16 v[134:135], v143 offset:3072
    ds_read_b64_tr_b16 v[136:137], v144 offset:2048
    ds_read_b64_tr_b16 v[138:139], v144 offset:3072
    s_waitcnt lgkmcnt(4)
    v_mfma_f32_32x32x16_bf16 v[4:19], v[124:127], v[68:71], v[4:19]
    v_mfma_f32_32x32x16_bf16 v[20:35], v[124:127], v[72:75], v[20:35]
    v_mfma_f32_32x32x16_bf16 v[36:51], v[128:131], v[68:71], v[36:51]
    v_mfma_f32_32x32x16_bf16 v[52:67], v[128:131], v[72:75], v[52:67]
    s_lshl_b32 s79, s77, 10
    s_add_u32 s79, s79, s74
    s_add_u32 s34, s79, 114688
    buffer_load_dwordx4 v[68:71], v140, s[48:51], s79 offen sc1
    buffer_load_dwordx4 v[72:75], v140, s[48:51], s34 offen sc1
    s_add_u32 s77, s77, 1
    s_cmp_eq_u32 s77, 28
    s_cselect_b32 s77, 0, s77
    s_lshl_b32 s80, s78, 14
    s_add_u32 m0, s76, 0
    s_add_u32 s80, s80, s75
    buffer_load_dwordx4 v141, s[52:55], s80 offen lds
    buffer_load_dwordx4 v142, s[52:55], s80 offen offset:1024 lds
    s_add_u32 s78, s78, 1
    s_cmp_eq_u32 s78, 28
    s_cselect_b32 s78, 0, s78
    s_waitcnt vmcnt(15)
    ds_read_b64_tr_b16 v[124:125], v143 offset:4096
    ds_read_b64_tr_b16 v[126:127], v143 offset:5120
    ds_read_b64_tr_b16 v[128:129], v144 offset:4096
    ds_read_b64_tr_b16 v[130:131], v144 offset:5120
    s_waitcnt lgkmcnt(4)
    v_mfma_f32_32x32x16_bf16 v[4:19], v[132:135], v[76:79], v[4:19]
    v_mfma_f32_32x32x16_bf16 v[20:35], v[132:135], v[80:83], v[20:35]
    v_mfma_f32_32x32x16_bf16 v[36:51], v[136:139], v[76:79], v[36:51]
    v_mfma_f32_32x32x16_bf16 v[52:67], v[136:139], v[80:83], v[52:67]
    s_lshl_b32 s79, s77, 10
    s_add_u32 s79, s79, s74
    s_add_u32 s34, s79, 114688
    buffer_load_dwordx4 v[76:79], v140, s[48:51], s79 offen sc1
    buffer_load_dwordx4 v[80:83], v140, s[48:51], s34 offen sc1
    s_add_u32 s77, s77, 1
    s_cmp_eq_u32 s77, 28
    s_cselect_b32 s77, 0, s77
    s_lshl_b32 s80, s78, 14
    s_add_u32 m0, s76, 2048
    s_add_u32 s80, s80, s75
    buffer_load_dwordx4 v141, s[52:55], s80 offen lds
    buffer_load_dwordx4 v142, s[52:55], s80 offen offset:1024 lds
    s_add_u32 s78, s78, 1
    s_cmp_eq_u32 s78, 28
    s_cselect_b32 s78, 0, s78
    s_waitcnt vmcnt(33)
    s_barrier
    s_waitcnt vmcnt(17)
    ds_read_b64_tr_b16 v[132:133], v143 offset:6144
    ds_read_b64_tr_b16 v[134:135], v143 offset:7168
    ds_read_b64_tr_b16 v[136:137], v144 offset:6144
    ds_read_b64_tr_b16 v[138:139], v144 offset:7168
    s_waitcnt lgkmcnt(4)
    v_mfma_f32_32x32x16_bf16 v[4:19], v[124:127], v[84:87], v[4:19]
    v_mfma_f32_32x32x16_bf16 v[20:35], v[124:127], v[88:91], v[20:35]
    v_mfma_f32_32x32x16_bf16 v[36:51], v[128:131], v[84:87], v[36:51]
    v_mfma_f32_32x32x16_bf16 v[52:67], v[128:131], v[88:91], v[52:67]
    s_lshl_b32 s79, s77, 10
    s_add_u32 s79, s79, s74
    s_add_u32 s34, s79, 114688
    buffer_load_dwordx4 v[84:87], v140, s[48:51], s79 offen sc1
    buffer_load_dwordx4 v[88:91], v140, s[48:51], s34 offen sc1
    s_add_u32 s77, s77, 1
    s_cmp_eq_u32 s77, 28
    s_cselect_b32 s77, 0, s77
    s_lshl_b32 s80, s78, 14
    s_add_u32 m0, s76, 4096
    s_add_u32 s80, s80, s75
    buffer_load_dwordx4 v141, s[52:55], s80 offen lds
    buffer_load_dwordx4 v142, s[52:55], s80 offen offset:1024 lds
    s_add_u32 s78, s78, 1
    s_cmp_eq_u32 s78, 28
    s_cselect_b32 s78, 0, s78
    s_waitcnt vmcnt(19)
    ds_read_b64_tr_b16 v[124:125], v143 offset:8192
    ds_read_b64_tr_b16 v[126:127], v143 offset:9216
    ds_read_b64_tr_b16 v[128:129], v144 offset:8192
    ds_read_b64_tr_b16 v[130:131], v144 offset:9216
    s_waitcnt lgkmcnt(4)
    v_mfma_f32_32x32x16_bf16 v[4:19], v[132:135], v[92:95], v[4:19]
    v_mfma_f32_32x32x16_bf16 v[20:35], v[132:135], v[96:99], v[20:35]
    v_mfma_f32_32x32x16_bf16 v[36:51], v[136:139], v[92:95], v[36:51]
    v_mfma_f32_32x32x16_bf16 v[52:67], v[136:139], v[96:99], v[52:67]
    s_lshl_b32 s79, s77, 10
    s_add_u32 s79, s79, s74
    s_add_u32 s34, s79, 114688
    buffer_load_dwordx4 v[92:95], v140, s[48:51], s79 offen sc1
    buffer_load_dwordx4 v[96:99], v140, s[48:51], s34 offen sc1
    s_add_u32 s77, s77, 1
    s_cmp_eq_u32 s77, 28
    s_cselect_b32 s77, 0, s77
    s_lshl_b32 s80, s78, 14
    s_add_u32 m0, s76, 6144
    s_add_u32 s80, s80, s75
    buffer_load_dwordx4 v141, s[52:55], s80 offen lds
    buffer_load_dwordx4 v142, s[52:55], s80 offen offset:1024 lds
    s_add_u32 s78, s78, 1
    s_cmp_eq_u32 s78, 28
    s_cselect_b32 s78, 0, s78
    s_waitcnt vmcnt(21)
    ds_read_b64_tr_b16 v[132:133], v143 offset:10240
    ds_read_b64_tr_b16 v[134:135], v143 offset:11264
    ds_read_b64_tr_b16 v[136:137], v144 offset:10240
    ds_read_b64_tr_b16 v[138:139], v144 offset:11264
    s_waitcnt lgkmcnt(4)
    v_mfma_f32_32x32x16_bf16 v[4:19], v[124:127], v[100:103], v[4:19]
    v_mfma_f32_32x32x16_bf16 v[20:35], v[124:127], v[104:107], v[20:35]
    v_mfma_f32_32x32x16_bf16 v[36:51], v[128:131], v[100:103], v[36:51]
    v_mfma_f32_32x32x16_bf16 v[52:67], v[128:131], v[104:107], v[52:67]
    s_lshl_b32 s79, s77, 10
    s_add_u32 s79, s79, s74
    s_add_u32 s34, s79, 114688
    buffer_load_dwordx4 v[100:103], v140, s[48:51], s79 offen sc1
    buffer_load_dwordx4 v[104:107], v140, s[48:51], s34 offen sc1
    s_add_u32 s77, s77, 1
    s_cmp_eq_u32 s77, 28
    s_cselect_b32 s77, 0, s77
    s_lshl_b32 s80, s78, 14
    s_add_u32 m0, s76, 8192
    s_add_u32 s80, s80, s75
    buffer_load_dwordx4 v141, s[52:55], s80 offen lds
    buffer_load_dwordx4 v142, s[52:55], s80 offen offset:1024 lds
    s_add_u32 s78, s78, 1
    s_cmp_eq_u32 s78, 28
    s_cselect_b32 s78, 0, s78
    s_waitcnt vmcnt(23)
    ds_read_b64_tr_b16 v[124:125], v143 offset:12288
    ds_read_b64_tr_b16 v[126:127], v143 offset:13312
    ds_read_b64_tr_b16 v[128:129], v144 offset:12288
    ds_read_b64_tr_b16 v[130:131], v144 offset:13312
    s_waitcnt lgkmcnt(4)
    v_mfma_f32_32x32x16_bf16 v[4:19], v[132:135], v[108:111], v[4:19]
    v_mfma_f32_32x32x16_bf16 v[20:35], v[132:135], v[112:115], v[20:35]
    v_mfma_f32_32x32x16_bf16 v[36:51], v[136:139], v[108:111], v[36:51]
    v_mfma_f32_32x32x16_bf16 v[52:67], v[136:139], v[112:115], v[52:67]
    s_lshl_b32 s79, s77, 10
    s_add_u32 s79, s79, s74
    s_add_u32 s34, s79, 114688
    buffer_load_dwordx4 v[108:111], v140, s[48:51], s79 offen sc1
    buffer_load_dwordx4 v[112:115], v140, s[48:51], s34 offen sc1
    s_add_u32 s77, s77, 1
    s_cmp_eq_u32 s77, 28
    s_cselect_b32 s77, 0, s77
    s_lshl_b32 s80, s78, 14
    s_add_u32 m0, s76, 10240
    s_add_u32 s80, s80, s75
    buffer_load_dwordx4 v141, s[52:55], s80 offen lds
    buffer_load_dwordx4 v142, s[52:55], s80 offen offset:1024 lds
    s_add_u32 s78, s78, 1
    s_cmp_eq_u32 s78, 28
    s_cselect_b32 s78, 0, s78
    s_waitcnt vmcnt(24)
    v_permlane32_swap_b32 v148, v150
    v_permlane32_swap_b32 v149, v151
    v_permlane32_swap_b32 v152, v154
    v_permlane32_swap_b32 v153, v155
    s_nop 1
    v_lshlrev_b32 v224, 16, v148
    v_and_b32 v225, 0xffff0000, v148
    v_lshlrev_b32 v226, 16, v149
    v_and_b32 v227, 0xffff0000, v149
    v_lshlrev_b32 v228, 16, v150
    v_and_b32 v229, 0xffff0000, v150
    v_lshlrev_b32 v230, 16, v151
    v_and_b32 v231, 0xffff0000, v151
    v_lshlrev_b32 v232, 16, v152
    v_and_b32 v233, 0xffff0000, v152
    v_lshlrev_b32 v234, 16, v153
    v_and_b32 v235, 0xffff0000, v153
    v_lshlrev_b32 v236, 16, v154
    v_and_b32 v237, 0xffff0000, v154
    v_lshlrev_b32 v238, 16, v155
    v_and_b32 v239, 0xffff0000, v155
    v_mul_f32 v224, v224, v157
    v_mul_f32 v225, v225, v157
    v_mul_f32 v226, v226, v157
    v_mul_f32 v227, v227, v157
    v_mul_f32 v228, v228, v157
    v_mul_f32 v229, v229, v157
    v_mul_f32 v230, v230, v157
    v_mul_f32 v231, v231, v157
    v_mul_f32 v232, v232, v157
    v_mul_f32 v233, v233, v157
    v_mul_f32 v234, v234, v157
    v_mul_f32 v235, v235, v157
    v_mul_f32 v236, v236, v157
    v_mul_f32 v237, v237, v157
    v_mul_f32 v238, v238, v157
    v_mul_f32 v239, v239, v157
    s_waitcnt vmcnt(25)
    s_waitcnt lgkmcnt(0)
    v_mfma_f32_32x32x16_bf16 v[4:19], v[124:127], v[116:119], v[4:19]
    v_mfma_f32_32x32x16_bf16 v[20:35], v[124:127], v[120:123], v[20:35]
    v_mfma_f32_32x32x16_bf16 v[36:51], v[128:131], v[116:119], v[36:51]
    v_mfma_f32_32x32x16_bf16 v[52:67], v[128:131], v[120:123], v[52:67]
    s_lshl_b32 s79, s77, 10
    s_add_u32 s79, s79, s74
    s_add_u32 s34, s79, 114688
    buffer_load_dwordx4 v[116:119], v140, s[48:51], s79 offen sc1
    buffer_load_dwordx4 v[120:123], v140, s[48:51], s34 offen sc1
    s_add_u32 s77, s77, 1
    s_cmp_eq_u32 s77, 28
    s_cselect_b32 s77, 0, s77
    s_lshl_b32 s80, s78, 14
    s_add_u32 m0, s76, 12288
    s_add_u32 s80, s80, s75
    buffer_load_dwordx4 v141, s[52:55], s80 offen lds
    buffer_load_dwordx4 v142, s[52:55], s80 offen offset:1024 lds
    s_add_u32 s78, s78, 1
    s_cmp_eq_u32 s78, 28
    s_cselect_b32 s78, 0, s78
    s_waitcnt vmcnt(26)
    s_waitcnt lgkmcnt(0)
    v_mfma_f32_32x32x16_bf16 v[4:19], v[160:163], v[68:71], v[4:19]
    v_mfma_f32_32x32x16_bf16 v[20:35], v[160:163], v[72:75], v[20:35]
    v_mfma_f32_32x32x16_bf16 v[36:51], v[164:167], v[68:71], v[36:51]
    v_mfma_f32_32x32x16_bf16 v[52:67], v[164:167], v[72:75], v[52:67]
    s_lshl_b32 s79, s77, 10
    s_add_u32 s79, s79, s74
    s_add_u32 s34, s79, 114688
    buffer_load_dwordx4 v[68:71], v140, s[48:51], s79 offen sc1
    buffer_load_dwordx4 v[72:75], v140, s[48:51], s34 offen sc1
    s_add_u32 s77, s77, 1
    s_cmp_eq_u32 s77, 28
    s_cselect_b32 s77, 0, s77
    s_waitcnt vmcnt(24)
    s_waitcnt lgkmcnt(0)
    v_mfma_f32_32x32x16_bf16 v[4:19], v[168:171], v[76:79], v[4:19]
    v_mfma_f32_32x32x16_bf16 v[20:35], v[168:171], v[80:83], v[20:35]
    v_mfma_f32_32x32x16_bf16 v[36:51], v[172:175], v[76:79], v[36:51]
    v_mfma_f32_32x32x16_bf16 v[52:67], v[172:175], v[80:83], v[52:67]
    s_lshl_b32 s79, s77, 10
    s_add_u32 s79, s79, s74
    s_add_u32 s34, s79, 114688
    buffer_load_dwordx4 v[76:79], v140, s[48:51], s79 offen sc1
    buffer_load_dwordx4 v[80:83], v140, s[48:51], s34 offen sc1
    s_add_u32 s77, s77, 1
    s_cmp_eq_u32 s77, 28
    s_cselect_b32 s77, 0, s77
    s_waitcnt vmcnt(22)
    s_waitcnt lgkmcnt(0)
    v_mfma_f32_32x32x16_bf16 v[4:19], v[176:179], v[84:87], v[4:19]
    v_mfma_f32_32x32x16_bf16 v[20:35], v[176:179], v[88:91], v[20:35]
    v_mfma_f32_32x32x16_bf16 v[36:51], v[180:183], v[84:87], v[36:51]
    v_mfma_f32_32x32x16_bf16 v[52:67], v[180:183], v[88:91], v[52:67]
    s_lshl_b32 s79, s77, 10
    s_add_u32 s79, s79, s74
    s_add_u32 s34, s79, 114688
    buffer_load_dwordx4 v[84:87], v140, s[48:51], s79 offen sc1
    buffer_load_dwordx4 v[88:91], v140, s[48:51], s34 offen sc1
    s_add_u32 s77, s77, 1
    s_cmp_eq_u32 s77, 28
    s_cselect_b32 s77, 0, s77
    s_waitcnt vmcnt(20)
    ds_read_b64_tr_b16 v[132:133], v143 offset:14336
    ds_read_b64_tr_b16 v[134:135], v143 offset:15360
    ds_read_b64_tr_b16 v[136:137], v144 offset:14336
    ds_read_b64_tr_b16 v[138:139], v144 offset:15360
    s_waitcnt lgkmcnt(4)
    v_mfma_f32_32x32x16_bf16 v[4:19], v[184:187], v[92:95], v[4:19]
    v_mfma_f32_32x32x16_bf16 v[20:35], v[184:187], v[96:99], v[20:35]
    v_mfma_f32_32x32x16_bf16 v[36:51], v[188:191], v[92:95], v[36:51]
    v_mfma_f32_32x32x16_bf16 v[52:67], v[188:191], v[96:99], v[52:67]
    s_lshl_b32 s79, s77, 10
    s_add_u32 s79, s79, s74
    s_add_u32 s34, s79, 114688
    buffer_load_dwordx4 v[92:95], v140, s[48:51], s79 offen sc1
    buffer_load_dwordx4 v[96:99], v140, s[48:51], s34 offen sc1
    s_add_u32 s77, s77, 1
    s_cmp_eq_u32 s77, 28
    s_cselect_b32 s77, 0, s77
    s_waitcnt vmcnt(18)
    ds_read_b64_tr_b16 v[124:125], v143 offset:16384
    ds_read_b64_tr_b16 v[126:127], v143 offset:17408
    ds_read_b64_tr_b16 v[128:129], v144 offset:16384
    ds_read_b64_tr_b16 v[130:131], v144 offset:17408
    s_waitcnt lgkmcnt(4)
    v_mfma_f32_32x32x16_bf16 v[4:19], v[132:135], v[100:103], v[4:19]
    v_mfma_f32_32x32x16_bf16 v[20:35], v[132:135], v[104:107], v[20:35]
    v_mfma_f32_32x32x16_bf16 v[36:51], v[136:139], v[100:103], v[36:51]
    v_mfma_f32_32x32x16_bf16 v[52:67], v[136:139], v[104:107], v[52:67]
    s_lshl_b32 s79, s77, 10
    s_add_u32 s79, s79, s74
    s_add_u32 s34, s79, 114688
    buffer_load_dwordx4 v[100:103], v140, s[48:51], s79 offen sc1
    buffer_load_dwordx4 v[104:107], v140, s[48:51], s34 offen sc1
    s_add_u32 s77, s77, 1
    s_cmp_eq_u32 s77, 28
    s_cselect_b32 s77, 0, s77
    s_lshl_b32 s80, s78, 14
    s_add_u32 m0, s76, 14336
    s_add_u32 s80, s80, s75
    buffer_load_dwordx4 v141, s[52:55], s80 offen lds
    buffer_load_dwordx4 v142, s[52:55], s80 offen offset:1024 lds
    s_add_u32 s78, s78, 1
    s_cmp_eq_u32 s78, 28
    s_cselect_b32 s78, 0, s78
    s_waitcnt vmcnt(18)
    ds_read_b64_tr_b16 v[132:133], v143 offset:18432
    ds_read_b64_tr_b16 v[134:135], v143 offset:19456
    ds_read_b64_tr_b16 v[136:137], v144 offset:18432
    ds_read_b64_tr_b16 v[138:139], v144 offset:19456
    s_waitcnt lgkmcnt(4)
    v_mfma_f32_32x32x16_bf16 v[4:19], v[124:127], v[108:111], v[4:19]
    v_mfma_f32_32x32x16_bf16 v[20:35], v[124:127], v[112:115], v[20:35]
    v_mfma_f32_32x32x16_bf16 v[36:51], v[128:131], v[108:111], v[36:51]
    v_mfma_f32_32x32x16_bf16 v[52:67], v[128:131], v[112:115], v[52:67]
    s_lshl_b32 s79, s77, 10
    s_add_u32 s79, s79, s74
    s_add_u32 s34, s79, 114688
    buffer_load_dwordx4 v[108:111], v140, s[48:51], s79 offen sc1
    buffer_load_dwordx4 v[112:115], v140, s[48:51], s34 offen sc1
    s_add_u32 s77, s77, 1
    s_cmp_eq_u32 s77, 28
    s_cselect_b32 s77, 0, s77
    s_lshl_b32 s80, s78, 14
    s_add_u32 m0, s76, 16384
    s_add_u32 s80, s80, s75
    buffer_load_dwordx4 v141, s[52:55], s80 offen lds
    buffer_load_dwordx4 v142, s[52:55], s80 offen offset:1024 lds
    s_add_u32 s78, s78, 1
    s_cmp_eq_u32 s78, 28
    s_cselect_b32 s78, 0, s78
    s_waitcnt vmcnt(18)
    ds_read_b64_tr_b16 v[124:125], v143 offset:20480
    ds_read_b64_tr_b16 v[126:127], v143 offset:21504
    ds_read_b64_tr_b16 v[128:129], v144 offset:20480
    ds_read_b64_tr_b16 v[130:131], v144 offset:21504
    s_waitcnt lgkmcnt(4)
    v_mfma_f32_32x32x16_bf16 v[4:19], v[132:135], v[116:119], v[4:19]
    v_mfma_f32_32x32x16_bf16 v[20:35], v[132:135], v[120:123], v[20:35]
    v_mfma_f32_32x32x16_bf16 v[36:51], v[136:139], v[116:119], v[36:51]
    v_mfma_f32_32x32x16_bf16 v[52:67], v[136:139], v[120:123], v[52:67]
    s_lshl_b32 s79, s77, 10
    s_add_u32 s79, s79, s74
    s_add_u32 s34, s79, 114688
    buffer_load_dwordx4 v[116:119], v140, s[48:51], s79 offen sc1
    buffer_load_dwordx4 v[120:123], v140, s[48:51], s34 offen sc1
    s_add_u32 s77, s77, 1
    s_cmp_eq_u32 s77, 28
    s_cselect_b32 s77, 0, s77
    s_lshl_b32 s80, s78, 14
    s_add_u32 m0, s76, 18432
    s_add_u32 s80, s80, s75
    buffer_load_dwordx4 v141, s[52:55], s80 offen lds
    buffer_load_dwordx4 v142, s[52:55], s80 offen offset:1024 lds
    s_add_u32 s78, s78, 1
    s_cmp_eq_u32 s78, 28
    s_cselect_b32 s78, 0, s78
    s_waitcnt vmcnt(18)
    ds_read_b64_tr_b16 v[132:133], v143 offset:0
    ds_read_b64_tr_b16 v[134:135], v143 offset:1024
    ds_read_b64_tr_b16 v[136:137], v144 offset:0
    ds_read_b64_tr_b16 v[138:139], v144 offset:1024
    s_waitcnt lgkmcnt(4)
    v_mfma_f32_32x32x16_bf16 v[4:19], v[124:127], v[68:71], v[4:19]
    v_mfma_f32_32x32x16_bf16 v[20:35], v[124:127], v[72:75], v[20:35]
    v_mfma_f32_32x32x16_bf16 v[36:51], v[128:131], v[68:71], v[36:51]
    v_mfma_f32_32x32x16_bf16 v[52:67], v[128:131], v[72:75], v[52:67]
    s_lshl_b32 s79, s77, 10
    s_add_u32 s79, s79, s74
    s_add_u32 s34, s79, 114688
    buffer_load_dwordx4 v[68:71], v140, s[48:51], s79 offen sc1
    buffer_load_dwordx4 v[72:75], v140, s[48:51], s34 offen sc1
    s_add_u32 s77, s77, 1
    s_cmp_eq_u32 s77, 28
    s_cselect_b32 s77, 0, s77
    s_lshl_b32 s80, s78, 14
    s_add_u32 m0, s76, 20480
    s_add_u32 s80, s80, s75
    buffer_load_dwordx4 v141, s[52:55], s80 offen lds
    buffer_load_dwordx4 v142, s[52:55], s80 offen offset:1024 lds
    s_add_u32 s78, s78, 1
    s_cmp_eq_u32 s78, 28
    s_cselect_b32 s78, 0, s78
    s_waitcnt vmcnt(20)
    ds_read_b64_tr_b16 v[124:125], v143 offset:2048
    ds_read_b64_tr_b16 v[126:127], v143 offset:3072
    ds_read_b64_tr_b16 v[128:129], v144 offset:2048
    ds_read_b64_tr_b16 v[130:131], v144 offset:3072
    s_waitcnt lgkmcnt(4)
    v_mfma_f32_32x32x16_bf16 v[4:19], v[132:135], v[76:79], v[4:19]
    v_mfma_f32_32x32x16_bf16 v[20:35], v[132:135], v[80:83], v[20:35]
    v_mfma_f32_32x32x16_bf16 v[36:51], v[136:139], v[76:79], v[36:51]
    v_mfma_f32_32x32x16_bf16 v[52:67], v[136:139], v[80:83], v[52:67]
    s_lshl_b32 s79, s77, 10
    s_add_u32 s79, s79, s74
    s_add_u32 s34, s79, 114688
    buffer_load_dwordx4 v[76:79], v140, s[48:51], s79 offen sc1
    buffer_load_dwordx4 v[80:83], v140, s[48:51], s34 offen sc1
    s_add_u32 s77, s77, 1
    s_cmp_eq_u32 s77, 28
    s_cselect_b32 s77, 0, s77
    s_lshl_b32 s80, s78, 14
    s_add_u32 m0, s76, 0
    s_add_u32 s80, s80, s75
    buffer_load_dwordx4 v141, s[52:55], s80 offen lds
    buffer_load_dwordx4 v142, s[52:55], s80 offen offset:1024 lds
    s_add_u32 s78, s78, 1
    s_cmp_eq_u32 s78, 28
    s_cselect_b32 s78, 0, s78
    s_waitcnt vmcnt(22)
    ds_read_b64_tr_b16 v[132:133], v143 offset:4096
    ds_read_b64_tr_b16 v[134:135], v143 offset:5120
    ds_read_b64_tr_b16 v[136:137], v144 offset:4096
    ds_read_b64_tr_b16 v[138:139], v144 offset:5120
    s_waitcnt lgkmcnt(4)
    v_mfma_f32_32x32x16_bf16 v[4:19], v[124:127], v[84:87], v[4:19]
    v_mfma_f32_32x32x16_bf16 v[20:35], v[124:127], v[88:91], v[20:35]
    v_mfma_f32_32x32x16_bf16 v[36:51], v[128:131], v[84:87], v[36:51]
    v_mfma_f32_32x32x16_bf16 v[52:67], v[128:131], v[88:91], v[52:67]
    s_lshl_b32 s79, s77, 10
    s_add_u32 s79, s79, s74
    s_add_u32 s34, s79, 114688
    buffer_load_dwordx4 v[84:87], v140, s[48:51], s79 offen sc1
    buffer_load_dwordx4 v[88:91], v140, s[48:51], s34 offen sc1
    s_add_u32 s77, s77, 1
    s_cmp_eq_u32 s77, 28
    s_cselect_b32 s77, 0, s77
    s_lshl_b32 s80, s78, 14
    s_add_u32 m0, s76, 2048
    s_add_u32 s80, s80, s75
    buffer_load_dwordx4 v141, s[52:55], s80 offen lds
    buffer_load_dwordx4 v142, s[52:55], s80 offen offset:1024 lds
    s_add_u32 s78, s78, 1
    s_cmp_eq_u32 s78, 28
    s_cselect_b32 s78, 0, s78
    s_waitcnt vmcnt(24)
    ds_read_b64_tr_b16 v[124:125], v143 offset:6144
    ds_read_b64_tr_b16 v[126:127], v143 offset:7168
    ds_read_b64_tr_b16 v[128:129], v144 offset:6144
    ds_read_b64_tr_b16 v[130:131], v144 offset:7168
    s_waitcnt lgkmcnt(4)
    v_mfma_f32_32x32x16_bf16 v[4:19], v[132:135], v[92:95], v[4:19]
    v_mfma_f32_32x32x16_bf16 v[20:35], v[132:135], v[96:99], v[20:35]
    v_mfma_f32_32x32x16_bf16 v[36:51], v[136:139], v[92:95], v[36:51]
    v_mfma_f32_32x32x16_bf16 v[52:67], v[136:139], v[96:99], v[52:67]
    s_lshl_b32 s79, s77, 10
    s_add_u32 s79, s79, s74
    s_add_u32 s34, s79, 114688
    buffer_load_dwordx4 v[92:95], v140, s[48:51], s79 offen sc1
    buffer_load_dwordx4 v[96:99], v140, s[48:51], s34 offen sc1
    s_add_u32 s77, s77, 1
    s_cmp_eq_u32 s77, 28
    s_cselect_b32 s77, 0, s77
    s_waitcnt vmcnt(24)
    ds_read_b64_tr_b16 v[132:133], v143 offset:8192
    ds_read_b64_tr_b16 v[134:135], v143 offset:9216
    ds_read_b64_tr_b16 v[136:137], v144 offset:8192
    ds_read_b64_tr_b16 v[138:139], v144 offset:9216
    s_waitcnt lgkmcnt(4)
    v_mfma_f32_32x32x16_bf16 v[4:19], v[124:127], v[100:103], v[4:19]
    v_mfma_f32_32x32x16_bf16 v[20:35], v[124:127], v[104:107], v[20:35]
    v_mfma_f32_32x32x16_bf16 v[36:51], v[128:131], v[100:103], v[36:51]
    v_mfma_f32_32x32x16_bf16 v[52:67], v[128:131], v[104:107], v[52:67]
    s_lshl_b32 s79, s77, 10
    s_add_u32 s79, s79, s74
    s_add_u32 s34, s79, 114688
    buffer_load_dwordx4 v[100:103], v140, s[48:51], s79 offen sc1
    buffer_load_dwordx4 v[104:107], v140, s[48:51], s34 offen sc1
    s_add_u32 s77, s77, 1
    s_cmp_eq_u32 s77, 28
    s_cselect_b32 s77, 0, s77
    s_waitcnt vmcnt(22)
    ds_read_b64_tr_b16 v[124:125], v143 offset:10240
    ds_read_b64_tr_b16 v[126:127], v143 offset:11264
    ds_read_b64_tr_b16 v[128:129], v144 offset:10240
    ds_read_b64_tr_b16 v[130:131], v144 offset:11264
    s_waitcnt lgkmcnt(4)
    v_mfma_f32_32x32x16_bf16 v[4:19], v[132:135], v[108:111], v[4:19]
    v_mfma_f32_32x32x16_bf16 v[20:35], v[132:135], v[112:115], v[20:35]
    v_mfma_f32_32x32x16_bf16 v[36:51], v[136:139], v[108:111], v[36:51]
    v_mfma_f32_32x32x16_bf16 v[52:67], v[136:139], v[112:115], v[52:67]
    s_lshl_b32 s79, s77, 10
    s_add_u32 s79, s79, s74
    s_add_u32 s34, s79, 114688
    buffer_load_dwordx4 v[108:111], v140, s[48:51], s79 offen sc1
    buffer_load_dwordx4 v[112:115], v140, s[48:51], s34 offen sc1
    s_add_u32 s77, s77, 1
    s_cmp_eq_u32 s77, 28
    s_cselect_b32 s77, 0, s77
    s_waitcnt vmcnt(20)
    ds_read_b64_tr_b16 v[132:133], v143 offset:12288
    ds_read_b64_tr_b16 v[134:135], v143 offset:13312
    ds_read_b64_tr_b16 v[136:137], v144 offset:12288
    ds_read_b64_tr_b16 v[138:139], v144 offset:13312
    s_waitcnt lgkmcnt(4)
    v_mfma_f32_32x32x16_bf16 v[4:19], v[124:127], v[116:119], v[4:19]
    v_mfma_f32_32x32x16_bf16 v[20:35], v[124:127], v[120:123], v[20:35]
    v_mfma_f32_32x32x16_bf16 v[36:51], v[128:131], v[116:119], v[36:51]
    v_mfma_f32_32x32x16_bf16 v[52:67], v[128:131], v[120:123], v[52:67]
    s_lshl_b32 s79, s77, 10
    s_add_u32 s79, s79, s74
    s_add_u32 s34, s79, 114688
    buffer_load_dwordx4 v[116:119], v140, s[48:51], s79 offen sc1
    buffer_load_dwordx4 v[120:123], v140, s[48:51], s34 offen sc1
    s_add_u32 s77, s77, 1
    s_cmp_eq_u32 s77, 28
    s_cselect_b32 s77, 0, s77
    s_waitcnt vmcnt(18)
    ds_read_b64_tr_b16 v[124:125], v143 offset:14336
    ds_read_b64_tr_b16 v[126:127], v143 offset:15360
    ds_read_b64_tr_b16 v[128:129], v144 offset:14336
    ds_read_b64_tr_b16 v[130:131], v144 offset:15360
    s_waitcnt lgkmcnt(4)
    v_mfma_f32_32x32x16_bf16 v[4:19], v[132:135], v[68:71], v[4:19]
    v_mfma_f32_32x32x16_bf16 v[20:35], v[132:135], v[72:75], v[20:35]
    v_mfma_f32_32x32x16_bf16 v[36:51], v[136:139], v[68:71], v[36:51]
    v_mfma_f32_32x32x16_bf16 v[52:67], v[136:139], v[72:75], v[52:67]
    s_waitcnt vmcnt(14)
    ds_read_b64_tr_b16 v[132:133], v143 offset:16384
    ds_read_b64_tr_b16 v[134:135], v143 offset:17408
    ds_read_b64_tr_b16 v[136:137], v144 offset:16384
    ds_read_b64_tr_b16 v[138:139], v144 offset:17408
    s_waitcnt lgkmcnt(4)
    v_mfma_f32_32x32x16_bf16 v[4:19], v[124:127], v[76:79], v[4:19]
    v_mfma_f32_32x32x16_bf16 v[20:35], v[124:127], v[80:83], v[20:35]
    v_mfma_f32_32x32x16_bf16 v[36:51], v[128:131], v[76:79], v[36:51]
    v_mfma_f32_32x32x16_bf16 v[52:67], v[128:131], v[80:83], v[52:67]
    s_waitcnt vmcnt(10)
    ds_read_b64_tr_b16 v[124:125], v143 offset:18432
    ds_read_b64_tr_b16 v[126:127], v143 offset:19456
    ds_read_b64_tr_b16 v[128:129], v144 offset:18432
    ds_read_b64_tr_b16 v[130:131], v144 offset:19456
    s_waitcnt lgkmcnt(4)
    v_mfma_f32_32x32x16_bf16 v[4:19], v[132:135], v[84:87], v[4:19]
    v_mfma_f32_32x32x16_bf16 v[20:35], v[132:135], v[88:91], v[20:35]
    v_mfma_f32_32x32x16_bf16 v[36:51], v[136:139], v[84:87], v[36:51]
    v_mfma_f32_32x32x16_bf16 v[52:67], v[136:139], v[88:91], v[52:67]
    s_waitcnt vmcnt(6)
    ds_read_b64_tr_b16 v[132:133], v143 offset:20480
    ds_read_b64_tr_b16 v[134:135], v143 offset:21504
    ds_read_b64_tr_b16 v[136:137], v144 offset:20480
    ds_read_b64_tr_b16 v[138:139], v144 offset:21504
    s_waitcnt lgkmcnt(4)
    v_mfma_f32_32x32x16_bf16 v[4:19], v[124:127], v[92:95], v[4:19]
    v_mfma_f32_32x32x16_bf16 v[20:35], v[124:127], v[96:99], v[20:35]
    v_mfma_f32_32x32x16_bf16 v[36:51], v[128:131], v[92:95], v[36:51]
    v_mfma_f32_32x32x16_bf16 v[52:67], v[128:131], v[96:99], v[52:67]
    s_waitcnt vmcnt(4)
    ds_read_b64_tr_b16 v[124:125], v143 offset:0
    ds_read_b64_tr_b16 v[126:127], v143 offset:1024
    ds_read_b64_tr_b16 v[128:129], v144 offset:0
    ds_read_b64_tr_b16 v[130:131], v144 offset:1024
    s_waitcnt lgkmcnt(4)
    v_mfma_f32_32x32x16_bf16 v[4:19], v[132:135], v[100:103], v[4:19]
    v_mfma_f32_32x32x16_bf16 v[20:35], v[132:135], v[104:107], v[20:35]
    v_mfma_f32_32x32x16_bf16 v[36:51], v[136:139], v[100:103], v[36:51]
    v_mfma_f32_32x32x16_bf16 v[52:67], v[136:139], v[104:107], v[52:67]
    s_waitcnt vmcnt(2)
    ds_read_b64_tr_b16 v[132:133], v143 offset:2048
    ds_read_b64_tr_b16 v[134:135], v143 offset:3072
    ds_read_b64_tr_b16 v[136:137], v144 offset:2048
    ds_read_b64_tr_b16 v[138:139], v144 offset:3072
    s_waitcnt lgkmcnt(4)
    v_mfma_f32_32x32x16_bf16 v[4:19], v[124:127], v[108:111], v[4:19]
    v_mfma_f32_32x32x16_bf16 v[20:35], v[124:127], v[112:115], v[20:35]
    v_mfma_f32_32x32x16_bf16 v[36:51], v[128:131], v[108:111], v[36:51]
    v_mfma_f32_32x32x16_bf16 v[52:67], v[128:131], v[112:115], v[52:67]
    s_waitcnt vmcnt(0)
    s_waitcnt lgkmcnt(0)
    v_mfma_f32_32x32x16_bf16 v[4:19], v[132:135], v[116:119], v[4:19]
    v_mfma_f32_32x32x16_bf16 v[20:35], v[132:135], v[120:123], v[20:35]
    v_mfma_f32_32x32x16_bf16 v[36:51], v[136:139], v[116:119], v[36:51]
    v_mfma_f32_32x32x16_bf16 v[52:67], v[136:139], v[120:123], v[52:67]
    s_nop 15
    v_lshlrev_b32 v84, 4, v0
    v_add_u32 v84, 90624, v84
    s_cmp_eq_u32 s33, 0
    s_cbranch_scc1 P3skip_4
    s_sub_u32 s34, s33, 1
    s_and_b32 s34, s34, 3
    s_lshl_b32 s34, s34, 12
    s_add_u32 s34, s34, 0
    v_add_u32 v85, s34, v84
    ds_write_b128 v85, v[4:7] offset:0
    ds_write_b128 v85, v[8:11] offset:1024
    ds_write_b128 v85, v[12:15] offset:2048
    ds_write_b128 v85, v[16:19] offset:3072
P3skip_4:
    s_cmp_eq_u32 s33, 1
    s_cbranch_scc1 P3skip_5
    s_sub_u32 s34, s33, 2
    s_and_b32 s34, s34, 3
    s_lshl_b32 s34, s34, 12
    s_add_u32 s34, s34, 12288
    v_add_u32 v85, s34, v84
    ds_write_b128 v85, v[20:23] offset:0
    ds_write_b128 v85, v[24:27] offset:1024
    ds_write_b128 v85, v[28:31] offset:2048
    ds_write_b128 v85, v[32:35] offset:3072
P3skip_5:
    s_cmp_eq_u32 s33, 2
    s_cbranch_scc1 P3skip_6
    s_sub_u32 s34, s33, 3
    s_and_b32 s34, s34, 3
    s_lshl_b32 s34, s34, 12
    s_add_u32 s34, s34, 24576
    v_add_u32 v85, s34, v84
    ds_write_b128 v85, v[36:39] offset:0
    ds_write_b128 v85, v[40:43] offset:1024
    ds_write_b128 v85, v[44:47] offset:2048
    ds_write_b128 v85, v[48:51] offset:3072
P3skip_6:
    s_cmp_eq_u32 s33, 3
    s_cbranch_scc1 P3skip_7
    s_sub_u32 s34, s33, 4
    s_and_b32 s34, s34, 3
    s_lshl_b32 s34, s34, 12
    s_add_u32 s34, s34, 36864
    v_add_u32 v85, s34, v84
    ds_write_b128 v85, v[52:55] offset:0
    ds_write_b128 v85, v[56:59] offset:1024
    ds_write_b128 v85, v[60:63] offset:2048
    ds_write_b128 v85, v[64:67] offset:3072
P3skip_7:
    s_cmp_lg_u32 s33, 1
    s_cbranch_scc1 P3own_8
    v_mov_b32 v4, v20
    v_mov_b32 v5, v21
    v_mov_b32 v6, v22
    v_mov_b32 v7, v23
    v_mov_b32 v8, v24
    v_mov_b32 v9, v25
    v_mov_b32 v10, v26
    v_mov_b32 v11, v27
    v_mov_b32 v12, v28
    v_mov_b32 v13, v29
    v_mov_b32 v14, v30
    v_mov_b32 v15, v31
    v_mov_b32 v16, v32
    v_mov_b32 v17, v33
    v_mov_b32 v18, v34
    v_mov_b32 v19, v35
P3own_8:
    s_cmp_lg_u32 s33, 2
    s_cbranch_scc1 P3own_9
    v_mov_b32 v4, v36
    v_mov_b32 v5, v37
    v_mov_b32 v6, v38
    v_mov_b32 v7, v39
    v_mov_b32 v8, v40
    v_mov_b32 v9, v41
    v_mov_b32 v10, v42
    v_mov_b32 v11, v43
    v_mov_b32 v12, v44
    v_mov_b32 v13, v45
    v_mov_b32 v14, v46
    v_mov_b32 v15, v47
    v_mov_b32 v16, v48
    v_mov_b32 v17, v49
    v_mov_b32 v18, v50
    v_mov_b32 v19, v51
P3own_9:
    s_cmp_lg_u32 s33, 3
    s_cbranch_scc1 P3own_10
    v_mov_b32 v4, v52
    v_mov_b32 v5, v53
    v_mov_b32 v6, v54
    v_mov_b32 v7, v55
    v_mov_b32 v8, v56
    v_mov_b32 v9, v57
    v_mov_b32 v10, v58
    v_mov_b32 v11, v59
    v_mov_b32 v12, v60
    v_mov_b32 v13, v61
    v_mov_b32 v14, v62
    v_mov_b32 v15, v63
    v_mov_b32 v16, v64
    v_mov_b32 v17, v65
    v_mov_b32 v18, v66
    v_mov_b32 v19, v67
P3own_10:
    s_waitcnt lgkmcnt(0)
    s_barrier
    s_mul_i32 s34, s33, 12288
    v_add_u32 v85, s34, v84
    ds_read_b128 v[20:23], v85 offset:0
    ds_read_b128 v[24:27], v85 offset:1024
    ds_read_b128 v[28:31], v85 offset:2048
    ds_read_b128 v[32:35], v85 offset:3072
    ds_read_b128 v[36:39], v85 offset:4096
    ds_read_b128 v[40:43], v85 offset:5120
    ds_read_b128 v[44:47], v85 offset:6144
    ds_read_b128 v[48:51], v85 offset:7168
    ds_read_b128 v[52:55], v85 offset:8192
    ds_read_b128 v[56:59], v85 offset:9216
    ds_read_b128 v[60:63], v85 offset:10240
    ds_read_b128 v[64:67], v85 offset:11264
    v_lshrrev_b32 v145, 5, v0
    v_lshlrev_b32 v145, 2, v145
    v_bfe_u32 v146, v0, 2, 2
    v_add_u32 v145, v145, v146
    v_lshlrev_b32 v85, 7, v145
    v_bfe_u32 v145, v0, 4, 1
    v_lshlrev_b32 v145, 1, v145
    v_bfe_u32 v146, v0, 1, 1
    v_add_u32 v145, v145, v146
    v_bfe_u32 v146, v0, 3, 1
    s_and_b32 s34, s33, 1
    v_xor_b32 v146, s34, v146
    v_lshlrev_b32 v146, 2, v146
    v_xor_b32 v145, v145, v146
    v_lshl_add_u32 v85, v145, 4, v85
    v_and_b32 v145, 1, v0
    v_lshl_add_u32 v85, v145, 3, v85
    s_lshr_b32 s34, s33, 1
    s_lshl_b32 s34, s34, 12
    s_add_u32 s34, s34, 142336
    v_add_u32 v85, s34, v85
    ds_read_b64_tr_b16 v[86:87], v85 offset:0
    ds_read_b64_tr_b16 v[88:89], v85 offset:1024
    ds_read_b64_tr_b16 v[90:91], v85 offset:2048
    ds_read_b64_tr_b16 v[92:93], v85 offset:3072
    s_waitcnt vmcnt(0)
    v_sub_f32 v94, 1.0, v157
    v_cvt_pk_bf16_f32 v94, v94, v94
    v_lshlrev_b32 v94, 16, v94
    s_waitcnt lgkmcnt(4)
    v_add_f32 v4, v4, v20
    v_add_f32 v5, v5, v21
    v_add_f32 v6, v6, v22
    v_add_f32 v7, v7, v23
    v_add_f32 v8, v8, v24
    v_add_f32 v9, v9, v25
    v_add_f32 v10, v10, v26
    v_add_f32 v11, v11, v27
    v_add_f32 v12, v12, v28
    v_add_f32 v13, v13, v29
    v_add_f32 v14, v14, v30
    v_add_f32 v15, v15, v31
    v_add_f32 v16, v16, v32
    v_add_f32 v17, v17, v33
    v_add_f32 v18, v18, v34
    v_add_f32 v19, v19, v35
    v_add_f32 v4, v4, v36
    v_add_f32 v5, v5, v37
    v_add_f32 v6, v6, v38
    v_add_f32 v7, v7, v39
    v_add_f32 v8, v8, v40
    v_add_f32 v9, v9, v41
    v_add_f32 v10, v10, v42
    v_add_f32 v11, v11, v43
    v_add_f32 v12, v12, v44
    v_add_f32 v13, v13, v45
    v_add_f32 v14, v14, v46
    v_add_f32 v15, v15, v47
    v_add_f32 v16, v16, v48
    v_add_f32 v17, v17, v49
    v_add_f32 v18, v18, v50
    v_add_f32 v19, v19, v51
    v_add_f32 v4, v4, v52
    v_add_f32 v5, v5, v53
    v_add_f32 v6, v6, v54
    v_add_f32 v7, v7, v55
    v_add_f32 v8, v8, v56
    v_add_f32 v9, v9, v57
    v_add_f32 v10, v10, v58
    v_add_f32 v11, v11, v59
    v_add_f32 v12, v12, v60
    v_add_f32 v13, v13, v61
    v_add_f32 v14, v14, v62
    v_add_f32 v15, v15, v63
    v_add_f32 v16, v16, v64
    v_add_f32 v17, v17, v65
    v_add_f32 v18, v18, v66
    v_add_f32 v19, v19, v67
    s_waitcnt lgkmcnt(0)
    v_lshlrev_b32 v145, 16, v86
    v_mul_f32 v145, v145, v224
    v_fma_f32 v4, v4, v94, v145
    v_and_b32 v146, 0xffff0000, v86
    v_mul_f32 v146, v146, v225
    v_fma_f32 v5, v5, v94, v146
    v_lshlrev_b32 v145, 16, v87
    v_mul_f32 v145, v145, v226
    v_fma_f32 v6, v6, v94, v145
    v_and_b32 v146, 0xffff0000, v87
    v_mul_f32 v146, v146, v227
    v_fma_f32 v7, v7, v94, v146
    v_cvt_pk_bf16_f32 v68, v4, v5
    v_cvt_pk_bf16_f32 v69, v6, v7
    v_lshlrev_b32 v145, 16, v88
    v_mul_f32 v145, v145, v228
    v_fma_f32 v8, v8, v94, v145
    v_and_b32 v146, 0xffff0000, v88
    v_mul_f32 v146, v146, v229
    v_fma_f32 v9, v9, v94, v146
    v_lshlrev_b32 v145, 16, v89
    v_mul_f32 v145, v145, v230
    v_fma_f32 v10, v10, v94, v145
    v_and_b32 v146, 0xffff0000, v89
    v_mul_f32 v146, v146, v231
    v_fma_f32 v11, v11, v94, v146
    v_cvt_pk_bf16_f32 v70, v8, v9
    v_cvt_pk_bf16_f32 v71, v10, v11
    v_lshlrev_b32 v145, 16, v90
    v_mul_f32 v145, v145, v232
    v_fma_f32 v12, v12, v94, v145
    v_and_b32 v146, 0xffff0000, v90
    v_mul_f32 v146, v146, v233
    v_fma_f32 v13, v13, v94, v146
    v_lshlrev_b32 v145, 16, v91
    v_mul_f32 v145, v145, v234
    v_fma_f32 v14, v14, v94, v145
    v_and_b32 v146, 0xffff0000, v91
    v_mul_f32 v146, v146, v235
    v_fma_f32 v15, v15, v94, v146
    v_cvt_pk_bf16_f32 v72, v12, v13
    v_cvt_pk_bf16_f32 v73, v14, v15
    v_lshlrev_b32 v145, 16, v92
    v_mul_f32 v145, v145, v236
    v_fma_f32 v16, v16, v94, v145
    v_and_b32 v146, 0xffff0000, v92
    v_mul_f32 v146, v146, v237
    v_fma_f32 v17, v17, v94, v146
    v_lshlrev_b32 v145, 16, v93
    v_mul_f32 v145, v145, v238
    v_fma_f32 v18, v18, v94, v145
    v_and_b32 v146, 0xffff0000, v93
    v_mul_f32 v146, v146, v239
    v_fma_f32 v19, v19, v94, v146
    v_cvt_pk_bf16_f32 v74, v16, v17
    v_cvt_pk_bf16_f32 v75, v18, v19
    s_mov_b32 s48, s26
    s_mov_b32 s49, s27
    s_mov_b32 s50, 2097152
    s_mov_b32 s51, 0x20000
    s_nop 1
    v_permlane32_swap_b32 v68, v70
    v_permlane32_swap_b32 v69, v71
    v_permlane32_swap_b32 v72, v74
    v_permlane32_swap_b32 v73, v75
    buffer_store_dwordx4 v[68:71], v156, s[48:51], 0 offen offset:0
    buffer_store_dwordx4 v[72:75], v156, s[48:51], 0 offen offset:32
    s_branch L_fin
L_aux:
    s_and_b32 s34, s2, 7
    s_lshr_b32 s35, s2, 3
    s_and_b32 s68, s34, 1
    s_lshl_b32 s68, s68, 3
    s_and_b32 s36, s35, 7
    s_add_u32 s68, s68, s36
    s_lshr_b32 s69, s34, 1
    s_lshl_b32 s69, s69, 2
    s_lshr_b32 s36, s35, 3
    s_add_u32 s69, s69, s36
    s_sub_u32 s70, s33, 4
    s_lshl_b32 s34, s68, 7
    s_lshl_b32 s35, s70, 5
    s_add_u32 s34, s34, s35
    s_lshl_b32 s34, s34, 10
    v_lshrrev_b32 v13, 3, v0
    v_lshlrev_b32 v13, 10, v13
    v_add_u32 v13, s34, v13
    v_and_b32 v14, 7, v0
    v_lshrrev_b32 v15, 4, v0
    v_xor_b32 v2, v15, v14
    v_lshlrev_b32 v2, 4, v2
    v_add_u32 v2, v2, v13
    v_or_b32 v3, 4, v15
    v_xor_b32 v3, v3, v14
    v_lshlrev_b32 v3, 4, v3
    v_add_u32 v3, v3, v13
    v_add_u32 v3, 7168, v3
    v_xor_b32 v4, v15, v14
    v_lshlrev_b32 v4, 4, v4
    v_add_u32 v4, v4, v13
    v_add_u32 v4, 14336, v4
    v_or_b32 v5, 4, v15
    v_xor_b32 v5, v5, v14
    v_lshlrev_b32 v5, 4, v5
    v_add_u32 v5, v5, v13
    v_add_u32 v5, 21504, v5
    s_waitcnt lgkmcnt(0)
    s_mov_b32 s48, s4
    s_mov_b32 s49, s5
    s_mov_b32 s50, 2097152
    s_mov_b32 s51, 0x20000
    s_lshl_b32 s77, s69, 1
    s_add_u32 s77, s77, s68
    s_and_b32 s77, s77, 7
    s_lshl_b32 s40, s77, 7
    s_lshl_b32 m0, s70, 12
    s_nop 0
    buffer_load_dwordx4 v2, s[48:51], s40 offen offset:0 lds
    buffer_load_dwordx4 v3, s[48:51], s40 offen offset:1024 lds
    buffer_load_dwordx4 v4, s[48:51], s40 offen offset:2048 lds
    buffer_load_dwordx4 v5, s[48:51], s40 offen offset:3072 lds
    s_cmp_lt_u32 s70, 2
    s_cselect_b32 s52, s18, s20
    s_cselect_b32 s53, s19, s21
    s_mov_b32 s54, 1835008
    s_mov_b32 s55, 0x20000
    s_and_b32 s34, s70, 1
    s_mul_i32 s34, s34, 448
    s_mul_i32 s35, s69, 224
    s_movk_i32 s36, 4682
    s_movk_i32 s37, 3584
    v_add_u32 v13, s34, v0
    v_mul_lo_u32 v14, v13, s36
    v_lshrrev_b32 v14, 16, v14
    v_mul_u32_u24 v15, 14, v14
    v_sub_u32 v15, v13, v15
    v_lshlrev_b32 v15, 4, v15
    v_mul_lo_u32 v14, v14, s37
    v_add3_u32 v6, v14, v15, s35
    v_add_u32 v13, s34, v0
    v_add_u32 v13, 64, v13
    v_mul_lo_u32 v14, v13, s36
    v_lshrrev_b32 v14, 16, v14
    v_mul_u32_u24 v15, 14, v14
    v_sub_u32 v15, v13, v15
    v_lshlrev_b32 v15, 4, v15
    v_mul_lo_u32 v14, v14, s37
    v_add3_u32 v7, v14, v15, s35
    v_subrev_u32 v7, 1024, v7
    v_add_u32 v13, s34, v0
    v_add_u32 v13, 128, v13
    v_mul_lo_u32 v14, v13, s36
    v_lshrrev_b32 v14, 16, v14
    v_mul_u32_u24 v15, 14, v14
    v_sub_u32 v15, v13, v15
    v_lshlrev_b32 v15, 4, v15
    v_mul_lo_u32 v14, v14, s37
    v_add3_u32 v8, v14, v15, s35
    v_subrev_u32 v8, 2048, v8
    v_add_u32 v13, s34, v0
    v_add_u32 v13, 192, v13
    v_mul_lo_u32 v14, v13, s36
    v_lshrrev_b32 v14, 16, v14
    v_mul_u32_u24 v15, 14, v14
    v_sub_u32 v15, v13, v15
    v_lshlrev_b32 v15, 4, v15
    v_mul_lo_u32 v14, v14, s37
    v_add3_u32 v9, v14, v15, s35
    v_subrev_u32 v9, 3072, v9
    v_add_u32 v13, s34, v0
    v_add_u32 v13, 256, v13
    v_mul_lo_u32 v14, v13, s36
    v_lshrrev_b32 v14, 16, v14
    v_mul_u32_u24 v15, 14, v14
    v_sub_u32 v15, v13, v15
    v_lshlrev_b32 v15, 4, v15
    v_mul_lo_u32 v14, v14, s37
    v_add3_u32 v10, v14, v15, s35
    v_add_u32 v13, s34, v0
    v_add_u32 v13, 320, v13
    v_mul_lo_u32 v14, v13, s36
    v_lshrrev_b32 v14, 16, v14
    v_mul_u32_u24 v15, 14, v14
    v_sub_u32 v15, v13, v15
    v_lshlrev_b32 v15, 4, v15
    v_mul_lo_u32 v14, v14, s37
    v_add3_u32 v11, v14, v15, s35
    v_subrev_u32 v11, 1024, v11
    v_add_u32 v13, s34, v0
    v_add_u32 v13, 384, v13
    v_mul_lo_u32 v14, v13, s36
    v_lshrrev_b32 v14, 16, v14
    v_mul_u32_u24 v15, 14, v14
    v_sub_u32 v15, v13, v15
    v_lshlrev_b32 v15, 4, v15
    v_mul_lo_u32 v14, v14, s37
    v_add3_u32 v12, v14, v15, s35
    v_subrev_u32 v12, 2048, v12
    s_lshl_b32 s73, s70, 12
    s_lshr_b32 s34, s70, 1
    s_mul_i32 s34, s34, 14464
    s_and_b32 s35, s70, 1
    s_mul_i32 s35, s35, 7168
    s_add_u32 s74, s34, s35
    s_add_u32 s74, s74, 16384
    s_mov_b32 s71, 0
    s_mov_b32 s72, 0
    s_mov_b32 s76, 0
    s_lshl_b32 s77, s69, 1
    s_add_u32 s77, s77, s68
    s_and_b32 s77, s77, 7
    s_mov_b32 s84, s28
    s_mov_b32 s85, s29
    s_mov_b32 s86, 256
    s_mov_b32 s87, 0x20000
    s_cmp_lg_u32 s33, 4
    s_cbranch_scc1 AXN_11
    s_cmp_lg_u32 s2, 0
    s_cbranch_scc1 AXN_11
    s_memrealtime s[34:35]
    s_waitcnt lgkmcnt(0)
    s_or_b32 s34, s34, 1
    v_mov_b32 v250, s34
    v_mov_b32 v251, 0
    buffer_store_dword v250, v251, s[84:87], 0 offen sc1
AXN_11:
    s_mov_b32 s32, s70
    s_lshl_b32 s71, s77, 7
    s_mul_i32 s72, s77, 229376
    s_add_u32 m0, s76, s73
    s_add_u32 s77, s77, 1
    s_add_u32 m0, s76, s74
    s_and_b32 s77, s77, 7
    buffer_load_dwordx4 v6, s[52:55], s72 offen offset:0 lds
    buffer_load_dwordx4 v7, s[52:55], s72 offen offset:1024 lds
    buffer_load_dwordx4 v8, s[52:55], s72 offen offset:2048 lds
    buffer_load_dwordx4 v9, s[52:55], s72 offen offset:3072 lds
    s_add_u32 m0, m0, 4096
    s_add_u32 s76, s76, 45312
    buffer_load_dwordx4 v10, s[52:55], s72 offen offset:0 lds
    buffer_load_dwordx4 v11, s[52:55], s72 offen offset:1024 lds
    buffer_load_dwordx4 v12, s[52:55], s72 offen offset:2048 lds
    s_cmp_eq_u32 s76, 135936
    s_cselect_b32 s76, 0, s76
    s_mov_b32 s56, s4
    s_mov_b32 s57, s5
    s_mov_b32 s58, 2097152
    s_mov_b32 s59, 0x20000
    s_mov_b32 s60, s24
    s_mov_b32 s61, s25
    s_mov_b32 s62, 1024
    s_mov_b32 s63, 0x20000
    s_lshl_b32 s78, s68, 7
    s_lshl_b32 s34, s69, 3
    s_add_u32 s78, s78, s34
    s_lshl_b32 s34, s32, 1
    s_add_u32 s78, s78, s34
    s_lshl_b32 s34, s78, 10
    v_lshlrev_b32 v28, 4, v0
    buffer_load_dwordx4 v[16:19], v28, s[56:59], s34 offen
    buffer_load_dwordx4 v[20:23], v28, s[56:59], s34 offen offset:1024
    buffer_load_dwordx4 v[24:27], v28, s[60:63], 0 offen
    s_lshl_b32 s71, s77, 7
    s_mul_i32 s72, s77, 229376
    s_add_u32 m0, s76, s73
    s_add_u32 s77, s77, 1
    buffer_load_dwordx4 v2, s[48:51], s71 offen offset:0 lds
    buffer_load_dwordx4 v3, s[48:51], s71 offen offset:1024 lds
    buffer_load_dwordx4 v4, s[48:51], s71 offen offset:2048 lds
    buffer_load_dwordx4 v5, s[48:51], s71 offen offset:3072 lds
    s_add_u32 m0, s76, s74
    s_and_b32 s77, s77, 7
    buffer_load_dwordx4 v6, s[52:55], s72 offen offset:0 lds
    buffer_load_dwordx4 v7, s[52:55], s72 offen offset:1024 lds
    buffer_load_dwordx4 v8, s[52:55], s72 offen offset:2048 lds
    buffer_load_dwordx4 v9, s[52:55], s72 offen offset:3072 lds
    s_add_u32 m0, m0, 4096
    s_add_u32 s76, s76, 45312
    buffer_load_dwordx4 v10, s[52:55], s72 offen offset:0 lds
    buffer_load_dwordx4 v11, s[52:55], s72 offen offset:1024 lds
    buffer_load_dwordx4 v12, s[52:55], s72 offen offset:2048 lds
    s_cmp_eq_u32 s76, 135936
    s_cselect_b32 s76, 0, s76
    v_mov_b32 v249, 0
    s_waitcnt vmcnt(14)
    s_barrier
    s_lshl_b32 s71, s77, 7
    s_mul_i32 s72, s77, 229376
    s_add_u32 m0, s76, s73
    s_add_u32 s77, s77, 1
    buffer_load_dwordx4 v2, s[48:51], s71 offen offset:0 lds
    buffer_load_dwordx4 v3, s[48:51], s71 offen offset:1024 lds
    buffer_load_dwordx4 v4, s[48:51], s71 offen offset:2048 lds
    buffer_load_dwordx4 v5, s[48:51], s71 offen offset:3072 lds
    s_add_u32 m0, s76, s74
    s_and_b32 s77, s77, 7
    buffer_load_dwordx4 v6, s[52:55], s72 offen offset:0 lds
    buffer_load_dwordx4 v7, s[52:55], s72 offen offset:1024 lds
    buffer_load_dwordx4 v8, s[52:55], s72 offen offset:2048 lds
    buffer_load_dwordx4 v9, s[52:55], s72 offen offset:3072 lds
    s_add_u32 m0, m0, 4096
    s_add_u32 s76, s76, 45312
    buffer_load_dwordx4 v10, s[52:55], s72 offen offset:0 lds
    buffer_load_dwordx4 v11, s[52:55], s72 offen offset:1024 lds
    buffer_load_dwordx4 v12, s[52:55], s72 offen offset:2048 lds
    s_cmp_eq_u32 s76, 135936
    s_cselect_b32 s76, 0, s76
    s_waitcnt vmcnt(22)
    v_lshlrev_b32 v32, 16, v24
    v_and_b32 v33, 0xffff0000, v24
    v_lshlrev_b32 v34, 16, v25
    v_and_b32 v35, 0xffff0000, v25
    v_lshlrev_b32 v36, 16, v26
    v_and_b32 v37, 0xffff0000, v26
    v_lshlrev_b32 v38, 16, v27
    v_and_b32 v39, 0xffff0000, v27
    v_lshlrev_b32 v40, 16, v16
    v_and_b32 v41, 0xffff0000, v16
    v_pk_mul_f32 v[40:41], v[40:41], v[32:33]
    v_cvt_pk_bf16_f32 v42, v40, v41
    v_lshlrev_b32 v44, 16, v42
    v_and_b32 v45, 0xffff0000, v42
    v_add_f32 v30, v44, v45
    v_lshlrev_b32 v40, 16, v17
    v_and_b32 v41, 0xffff0000, v17
    v_pk_mul_f32 v[40:41], v[40:41], v[34:35]
    v_cvt_pk_bf16_f32 v42, v40, v41
    v_lshlrev_b32 v44, 16, v42
    v_and_b32 v45, 0xffff0000, v42
    v_add_f32 v30, v30, v44
    v_add_f32 v30, v30, v45
    v_lshlrev_b32 v40, 16, v18
    v_and_b32 v41, 0xffff0000, v18
    v_pk_mul_f32 v[40:41], v[40:41], v[36:37]
    v_cvt_pk_bf16_f32 v42, v40, v41
    v_lshlrev_b32 v44, 16, v42
    v_and_b32 v45, 0xffff0000, v42
    v_add_f32 v30, v30, v44
    v_add_f32 v30, v30, v45
    v_lshlrev_b32 v40, 16, v19
    v_and_b32 v41, 0xffff0000, v19
    v_pk_mul_f32 v[40:41], v[40:41], v[38:39]
    v_cvt_pk_bf16_f32 v42, v40, v41
    v_lshlrev_b32 v44, 16, v42
    v_and_b32 v45, 0xffff0000, v42
    v_add_f32 v30, v30, v44
    v_add_f32 v30, v30, v45
    v_lshlrev_b32 v40, 16, v20
    v_and_b32 v41, 0xffff0000, v20
    v_pk_mul_f32 v[40:41], v[40:41], v[32:33]
    v_cvt_pk_bf16_f32 v42, v40, v41
    v_lshlrev_b32 v44, 16, v42
    v_and_b32 v45, 0xffff0000, v42
    v_add_f32 v31, v44, v45
    v_lshlrev_b32 v40, 16, v21
    v_and_b32 v41, 0xffff0000, v21
    v_pk_mul_f32 v[40:41], v[40:41], v[34:35]
    v_cvt_pk_bf16_f32 v42, v40, v41
    v_lshlrev_b32 v44, 16, v42
    v_and_b32 v45, 0xffff0000, v42
    v_add_f32 v31, v31, v44
    v_add_f32 v31, v31, v45
    v_lshlrev_b32 v40, 16, v22
    v_and_b32 v41, 0xffff0000, v22
    v_pk_mul_f32 v[40:41], v[40:41], v[36:37]
    v_cvt_pk_bf16_f32 v42, v40, v41
    v_lshlrev_b32 v44, 16, v42
    v_and_b32 v45, 0xffff0000, v42
    v_add_f32 v31, v31, v44
    v_add_f32 v31, v31, v45
    v_lshlrev_b32 v40, 16, v23
    v_and_b32 v41, 0xffff0000, v23
    v_pk_mul_f32 v[40:41], v[40:41], v[38:39]
    v_cvt_pk_bf16_f32 v42, v40, v41
    v_lshlrev_b32 v44, 16, v42
    v_and_b32 v45, 0xffff0000, v42
    v_add_f32 v31, v31, v44
    v_add_f32 v31, v31, v45
    s_nop 0
    v_add_f32_dpp v30, v30, v30 row_shr:1 row_mask:0xf bank_mask:0xf bound_ctrl:0
    v_add_f32_dpp v31, v31, v31 row_shr:1 row_mask:0xf bank_mask:0xf bound_ctrl:0
    s_nop 0
    v_add_f32_dpp v30, v30, v30 row_shr:2 row_mask:0xf bank_mask:0xf bound_ctrl:0
    v_add_f32_dpp v31, v31, v31 row_shr:2 row_mask:0xf bank_mask:0xf bound_ctrl:0
    s_nop 0
    v_add_f32_dpp v30, v30, v30 row_shr:4 row_mask:0xf bank_mask:0xf bound_ctrl:0
    v_add_f32_dpp v31, v31, v31 row_shr:4 row_mask:0xf bank_mask:0xf bound_ctrl:0
    s_nop 0
    v_add_f32_dpp v30, v30, v30 row_shr:8 row_mask:0xf bank_mask:0xf bound_ctrl:0
    v_add_f32_dpp v31, v31, v31 row_shr:8 row_mask:0xf bank_mask:0xf bound_ctrl:0
    s_nop 0
    v_add_f32_dpp v30, v30, v30 row_bcast:15 row_mask:0xa bank_mask:0xf
    v_add_f32_dpp v31, v31, v31 row_bcast:15 row_mask:0xa bank_mask:0xf
    s_nop 0
    v_add_f32_dpp v30, v30, v30 row_bcast:31 row_mask:0xc bank_mask:0xf
    v_add_f32_dpp v31, v31, v31 row_bcast:31 row_mask:0xc bank_mask:0xf
    s_nop 1
    v_cvt_pk_bf16_f32 v42, v30, v31
    v_lshlrev_b32 v30, 16, v42
    v_and_b32 v31, 0xffff0000, v42
    s_mov_b32 s34, 0xbfb8aa3b
    v_mul_f32 v30, s34, v30
    v_mul_f32 v31, s34, v31
    v_exp_f32 v30, v30
    v_exp_f32 v31, v31
    s_nop 0
    v_add_f32 v30, 1.0, v30
    v_add_f32 v31, 1.0, v31
    v_rcp_f32 v30, v30
    v_rcp_f32 v31, v31
    s_nop 0
    v_cvt_pk_bf16_f32 v42, v30, v31
    v_lshlrev_b32 v30, 16, v42
    v_and_b32 v31, 0xffff0000, v42
    s_add_u32 s60, s30, 2097152
    s_addc_u32 s61, s31, 0
    s_mov_b32 s62, 8192
    s_mov_b32 s63, 0x20000
    s_lshl_b32 s34, s78, 2
    v_mov_b32 v28, 0
    v_cmp_eq_u32 vcc, 63, v0
    s_and_saveexec_b64 s[36:37], vcc
    buffer_store_dwordx2 v[30:31], v28, s[60:63], s34 offen sc1
    s_mov_b64 exec, s[36:37]
    s_lshl_b32 s34, s32, 4
    v_lshrrev_b32 v58, 3, v0
    v_add_u32 v58, s34, v58
    v_and_b32 v57, 7, v0
    v_add_u32 v56, 0, v58
    v_lshrrev_b32 v48, 3, v56
    v_xor_b32 v48, v48, v57
    v_lshlrev_b32 v48, 4, v48
    v_lshl_add_u32 v56, v56, 7, v48
    v_add_u32 v56, 135936, v56
    ds_read_b128 v[48:51], v56
    v_add_u32 v56, 8, v58
    v_lshrrev_b32 v52, 3, v56
    v_xor_b32 v52, v52, v57
    v_lshlrev_b32 v52, 4, v52
    v_lshl_add_u32 v56, v56, 7, v52
    v_add_u32 v56, 135936, v56
    ds_read_b128 v[52:55], v56
    s_mov_b32 s60, s30
    s_mov_b32 s61, s31
    s_mov_b32 s62, 2097152
    s_mov_b32 s63, 0x20000
    s_and_b32 s34, s2, 7
    s_lshl_b32 s34, s34, 2
    s_add_u32 s34, s34, s32
    s_lshl_b32 s34, s34, 16
    s_lshr_b32 s35, s2, 3
    s_lshl_b32 s35, s35, 7
    s_sub_u32 s35, 3968, s35
    s_add_u32 s34, s34, s35
    s_add_u32 s35, s34, 32768
    v_lshrrev_b32 v58, 3, v0
    v_lshlrev_b32 v58, 12, v58
    v_lshl_add_u32 v57, v57, 4, v58
    s_waitcnt lgkmcnt(1)
    buffer_store_dwordx4 v[48:51], v57, s[60:63], s34 offen sc1
    s_waitcnt lgkmcnt(0)
    buffer_store_dwordx4 v[52:55], v57, s[60:63], s35 offen sc1
    s_waitcnt vmcnt(13)
    s_barrier
    s_lshl_b32 s71, s77, 7
    s_mul_i32 s72, s77, 229376
    s_add_u32 m0, s76, s73
    s_add_u32 s77, s77, 1
    buffer_load_dwordx4 v2, s[48:51], s71 offen offset:0 lds
    buffer_load_dwordx4 v3, s[48:51], s71 offen offset:1024 lds
    buffer_load_dwordx4 v4, s[48:51], s71 offen offset:2048 lds
    buffer_load_dwordx4 v5, s[48:51], s71 offen offset:3072 lds
    s_add_u32 m0, s76, s74
    s_and_b32 s77, s77, 7
    buffer_load_dwordx4 v6, s[52:55], s72 offen offset:0 lds
    buffer_load_dwordx4 v7, s[52:55], s72 offen offset:1024 lds
    buffer_load_dwordx4 v8, s[52:55], s72 offen offset:2048 lds
    buffer_load_dwordx4 v9, s[52:55], s72 offen offset:3072 lds
    s_add_u32 m0, m0, 4096
    s_add_u32 s76, s76, 45312
    buffer_load_dwordx4 v10, s[52:55], s72 offen offset:0 lds
    buffer_load_dwordx4 v11, s[52:55], s72 offen offset:1024 lds
    buffer_load_dwordx4 v12, s[52:55], s72 offen offset:2048 lds
    s_cmp_eq_u32 s76, 135936
    s_cselect_b32 s76, 0, s76
    s_mov_b32 s56, s22
    s_mov_b32 s57, s23
    s_mov_b32 s58, 1835008
    s_mov_b32 s59, 0x20000
    s_mul_i32 s34, s2, 7168
    s_lshl_b32 s35, s32, 11
    s_add_u32 s34, s34, s35
    v_lshlrev_b32 v246, 4, v0
    buffer_load_dwordx4 v[240:243], v246, s[56:59], s34 offen
    s_cmp_eq_u32 s32, 3
    s_cbranch_scc1 MP_12
    buffer_load_dwordx4 v[240:243], v246, s[56:59], s34 offen offset:1024
MP_12:
    s_cmp_lg_u32 s33, 4
    s_cbranch_scc1 AXW_13
    buffer_load_dword v248, v249, s[84:87], 0 offen sc1
AXW_13:
    s_waitcnt vmcnt(13)
    s_barrier
    s_lshl_b32 s71, s77, 7
    s_mul_i32 s72, s77, 229376
    s_add_u32 m0, s76, s73
    s_add_u32 s77, s77, 1
    buffer_load_dwordx4 v2, s[48:51], s71 offen offset:0 lds
    buffer_load_dwordx4 v3, s[48:51], s71 offen offset:1024 lds
    buffer_load_dwordx4 v4, s[48:51], s71 offen offset:2048 lds
    buffer_load_dwordx4 v5, s[48:51], s71 offen offset:3072 lds
    s_add_u32 m0, s76, s74
    s_and_b32 s77, s77, 7
    buffer_load_dwordx4 v6, s[52:55], s72 offen offset:0 lds
    buffer_load_dwordx4 v7, s[52:55], s72 offen offset:1024 lds
    buffer_load_dwordx4 v8, s[52:55], s72 offen offset:2048 lds
    buffer_load_dwordx4 v9, s[52:55], s72 offen offset:3072 lds
    s_add_u32 m0, m0, 4096
    s_add_u32 s76, s76, 45312
    buffer_load_dwordx4 v10, s[52:55], s72 offen offset:0 lds
    buffer_load_dwordx4 v11, s[52:55], s72 offen offset:1024 lds
    buffer_load_dwordx4 v12, s[52:55], s72 offen offset:2048 lds
    s_cmp_eq_u32 s76, 135936
    s_cselect_b32 s76, 0, s76
    s_waitcnt vmcnt(11)
    s_barrier
    s_lshl_b32 s71, s77, 7
    s_mul_i32 s72, s77, 229376
    s_add_u32 m0, s76, s73
    s_add_u32 s77, s77, 1
    buffer_load_dwordx4 v2, s[48:51], s71 offen offset:0 lds
    buffer_load_dwordx4 v3, s[48:51], s71 offen offset:1024 lds
    buffer_load_dwordx4 v4, s[48:51], s71 offen offset:2048 lds
    buffer_load_dwordx4 v5, s[48:51], s71 offen offset:3072 lds
    s_add_u32 m0, s76, s74
    s_and_b32 s77, s77, 7
    buffer_load_dwordx4 v6, s[52:55], s72 offen offset:0 lds
    buffer_load_dwordx4 v7, s[52:55], s72 offen offset:1024 lds
    buffer_load_dwordx4 v8, s[52:55], s72 offen offset:2048 lds
    buffer_load_dwordx4 v9, s[52:55], s72 offen offset:3072 lds
    s_add_u32 m0, m0, 4096
    s_add_u32 s76, s76, 45312
    buffer_load_dwordx4 v10, s[52:55], s72 offen offset:0 lds
    buffer_load_dwordx4 v11, s[52:55], s72 offen offset:1024 lds
    buffer_load_dwordx4 v12, s[52:55], s72 offen offset:2048 lds
    s_cmp_eq_u32 s76, 135936
    s_cselect_b32 s76, 0, s76
    s_cmp_lg_u32 s33, 4
    s_cbranch_scc1 AXW_14
    s_mov_b32 s36, 4194304
AXS_16:
    v_readfirstlane_b32 s83, v248
    s_nop 3
    s_cmp_lg_u32 s83, 0
    s_cbranch_scc1 AXG_15
    buffer_load_dword v248, v249, s[84:87], 0 offen sc1
    s_waitcnt vmcnt(0)
    s_sub_u32 s36, s36, 1
    s_cmp_lg_u32 s36, 0
    s_cbranch_scc1 AXS_16
AXG_15:
    s_add_u32 s84, s30, 12582912
    s_addc_u32 s85, s31, 0
    s_mov_b32 s86, 98304
    s_mov_b32 s87, 0x20000
    v_mov_b32 v250, s83
    s_lshl_b32 s34, s2, 7
    s_add_u32 s34, s34, 0
    v_mov_b32 v251, s34
    v_cmp_eq_u32 vcc, 0, v0
    s_and_saveexec_b64 s[34:35], vcc
    buffer_store_dword v250, v251, s[84:87], 0 offen sc1
    s_mov_b64 exec, s[34:35]
AXW_14:
    s_waitcnt vmcnt(11)
    s_barrier
    s_lshl_b32 s71, s77, 7
    s_mul_i32 s72, s77, 229376
    s_add_u32 m0, s76, s73
    s_add_u32 s77, s77, 1
    buffer_load_dwordx4 v2, s[48:51], s71 offen offset:0 lds
    buffer_load_dwordx4 v3, s[48:51], s71 offen offset:1024 lds
    buffer_load_dwordx4 v4, s[48:51], s71 offen offset:2048 lds
    buffer_load_dwordx4 v5, s[48:51], s71 offen offset:3072 lds
    s_add_u32 m0, s76, s74
    s_and_b32 s77, s77, 7
    buffer_load_dwordx4 v6, s[52:55], s72 offen offset:0 lds
    buffer_load_dwordx4 v7, s[52:55], s72 offen offset:1024 lds
    buffer_load_dwordx4 v8, s[52:55], s72 offen offset:2048 lds
    buffer_load_dwordx4 v9, s[52:55], s72 offen offset:3072 lds
    s_add_u32 m0, m0, 4096
    s_add_u32 s76, s76, 45312
    buffer_load_dwordx4 v10, s[52:55], s72 offen offset:0 lds
    buffer_load_dwordx4 v11, s[52:55], s72 offen offset:1024 lds
    buffer_load_dwordx4 v12, s[52:55], s72 offen offset:2048 lds
    s_cmp_eq_u32 s76, 135936
    s_cselect_b32 s76, 0, s76
    s_waitcnt vmcnt(11)
    s_barrier
    s_lshl_b32 s71, s77, 7
    s_mul_i32 s72, s77, 229376
    s_add_u32 m0, s76, s73
    s_add_u32 s77, s77, 1
    buffer_load_dwordx4 v2, s[48:51], s71 offen offset:0 lds
    buffer_load_dwordx4 v3, s[48:51], s71 offen offset:1024 lds
    buffer_load_dwordx4 v4, s[48:51], s71 offen offset:2048 lds
    buffer_load_dwordx4 v5, s[48:51], s71 offen offset:3072 lds
    s_add_u32 m0, s76, s74
    s_and_b32 s77, s77, 7
    buffer_load_dwordx4 v6, s[52:55], s72 offen offset:0 lds
    buffer_load_dwordx4 v7, s[52:55], s72 offen offset:1024 lds
    buffer_load_dwordx4 v8, s[52:55], s72 offen offset:2048 lds
    buffer_load_dwordx4 v9, s[52:55], s72 offen offset:3072 lds
    s_add_u32 m0, m0, 4096
    s_add_u32 s76, s76, 45312
    buffer_load_dwordx4 v10, s[52:55], s72 offen offset:0 lds
    buffer_load_dwordx4 v11, s[52:55], s72 offen offset:1024 lds
    buffer_load_dwordx4 v12, s[52:55], s72 offen offset:2048 lds
    s_cmp_eq_u32 s76, 135936
    s_cselect_b32 s76, 0, s76
    s_waitcnt vmcnt(11)
    s_barrier
    s_and_b32 s70, s2, 7
    s_lshl_b32 s70, s70, 5
    s_lshr_b32 s34, s2, 3
    s_add_u32 s70, s70, s34
    s_lshr_b32 s34, s32, 1
    s_lshl_b32 s68, s70, 1
    s_add_u32 s68, s68, s34
    s_mul_i32 s69, s34, 25792
    s_add_u32 s69, s69, 90624
    s_lshl_b32 s35, s68, 12
    s_add_u32 s56, s12, s35
    s_addc_u32 s57, s13, 0
    s_mov_b32 s58, 4096
    s_mov_b32 s59, 0x20000
    s_add_u32 s60, s30, s35
    s_addc_u32 s61, s31, 0
    s_mov_b32 s62, 4112
    s_mov_b32 s63, 0x20000
    v_lshlrev_b32 v59, 4, v0
    s_and_b32 s36, s32, 1
    s_lshl_b32 s37, s36, 1
    s_mul_i32 s38, s37, 4160
    s_add_u32 s38, s38, s69
    s_add_u32 m0, s38, 64
    s_lshl_b32 s37, s37, 2
    s_add_u32 s37, s37, 4
    buffer_load_dwordx4 v59, s[56:59], s37 offen offset:0 lds
    buffer_load_dwordx4 v59, s[56:59], s37 offen offset:1024 lds
    buffer_load_dwordx4 v59, s[56:59], s37 offen offset:2048 lds
    buffer_load_dwordx4 v59, s[56:59], s37 offen offset:3072 lds
    s_lshl_b32 s37, s36, 1
    s_add_u32 s37, s37, 1
    s_mul_i32 s38, s37, 4160
    s_add_u32 s38, s38, s69
    s_add_u32 m0, s38, 64
    s_lshl_b32 s37, s37, 2
    s_add_u32 s37, s37, 4
    buffer_load_dwordx4 v59, s[56:59], s37 offen offset:0 lds
    buffer_load_dwordx4 v59, s[56:59], s37 offen offset:1024 lds
    buffer_load_dwordx4 v59, s[56:59], s37 offen offset:2048 lds
    buffer_load_dwordx4 v59, s[56:59], s37 offen offset:3072 lds
    v_lshrrev_b32 v62, 4, v0
    v_and_b32 v60, 15, v0
    v_add_u32 v60, v60, v62
    v_subrev_u32 v60, 15, v60
    v_lshlrev_b32 v60, 2, v60
    buffer_load_dword v61, v60, s[56:59], 0 offen
    v_and_b32 v63, 31, v0
    v_lshlrev_b32 v63, 3, v63
    s_and_b32 s34, s2, 7
    v_add_u32 v63, s34, v63
    s_waitcnt vmcnt(9)
    s_barrier
    s_and_b32 s34, s2, 7
    s_lshr_b32 s35, s2, 3
    s_lshl_b32 s71, s34, 2
    s_and_b32 s36, s35, 3
    s_add_u32 s71, s71, s36
    s_lshr_b32 s72, s35, 2
    s_mul_i32 s73, s72, 3
    s_and_b32 s34, s71, 3
    s_mul_i32 s34, s34, 7
    s_add_u32 s73, s73, s34
    s_cmp_ge_u32 s73, 28
    s_cselect_b32 s34, 28, 0
    s_sub_u32 s73, s73, s34
    v_lshrrev_b32 v70, 3, v0
    v_bfe_u32 v71, v0, 4, 1
    v_lshlrev_b32 v71, 2, v71
    v_and_b32 v68, 7, v0
    v_xor_b32 v68, v68, v71
    v_lshlrev_b32 v68, 4, v68
    v_lshl_add_u32 v68, v70, 10, v68
    s_lshl_b32 s34, s72, 7
    v_add_u32 v68, s34, v68
    v_add_u32 v69, 7168, v68
    s_mov_b32 s52, s22
    s_mov_b32 s53, s23
    s_mov_b32 s54, 1835008
    s_mov_b32 s55, 0x20000
    s_cmp_lg_u32 s33, 4
    s_cbranch_scc1 AXX_17
    v_lshlrev_b32 v253, 7, v63
    v_add_u32 v253, 0, v253
    s_mov_b32 s36, 4194304
POLL_18:
    buffer_load_dword v252, v253, s[84:87], 0 offen sc1
    s_waitcnt vmcnt(0)
    v_cmp_eq_u32 vcc, s83, v252
    s_nop 1
    s_cmp_eq_u64 vcc, exec
    s_cbranch_scc1 POLLOK_19
    s_sleep 2
    s_sub_u32 s36, s36, 1
    s_cmp_lg_u32 s36, 0
    s_cbranch_scc1 POLL_18
POLLOK_19:
    s_mov_b32 s62, 8208
    s_mov_b32 m0, 107264
    s_mov_b32 s37, 0
    buffer_load_dwordx4 v59, s[60:63], s37 offen offset:0 sc1 lds
    buffer_load_dwordx4 v59, s[60:63], s37 offen offset:1024 sc1 lds
    buffer_load_dwordx4 v59, s[60:63], s37 offen offset:2048 sc1 lds
    buffer_load_dwordx4 v59, s[60:63], s37 offen offset:3072 sc1 lds
    s_mov_b32 m0, 111840
    s_mov_b32 s37, 2
    buffer_load_dwordx4 v59, s[60:63], s37 offen offset:0 sc1 lds
    buffer_load_dwordx4 v59, s[60:63], s37 offen offset:1024 sc1 lds
    buffer_load_dwordx4 v59, s[60:63], s37 offen offset:2048 sc1 lds
    buffer_load_dwordx4 v59, s[60:63], s37 offen offset:3072 sc1 lds
    s_mov_b32 m0, 133056
    s_mov_b32 s37, 4096
    buffer_load_dwordx4 v59, s[60:63], s37 offen offset:0 sc1 lds
    buffer_load_dwordx4 v59, s[60:63], s37 offen offset:1024 sc1 lds
    buffer_load_dwordx4 v59, s[60:63], s37 offen offset:2048 sc1 lds
    buffer_load_dwordx4 v59, s[60:63], s37 offen offset:3072 sc1 lds
    s_mov_b32 m0, 137632
    s_mov_b32 s37, 4098
    buffer_load_dwordx4 v59, s[60:63], s37 offen offset:0 sc1 lds
    buffer_load_dwordx4 v59, s[60:63], s37 offen offset:1024 sc1 lds
    buffer_load_dwordx4 v59, s[60:63], s37 offen offset:2048 sc1 lds
    buffer_load_dwordx4 v59, s[60:63], s37 offen offset:3072 sc1 lds
AXX_17:
    v_mov_b32 v64, 0
    v_mov_b32 v65, 0
    v_mov_b32 v66, 0
    v_mov_b32 v67, 0
    v_cmp_gt_u32 vcc, 28, v0
    v_mov_b32 v62, 24864
    v_mov_b32 v60, 20736
    v_cndmask_b32 v62, v62, v60, vcc
    v_add3_u32 v62, v62, v59, s69
    v_cmp_gt_u32 vcc, 56, v0
    s_and_saveexec_b64 s[38:39], vcc
    ds_write_b128 v62, v[64:67]
    s_mov_b64 exec, s[38:39]
    v_lshrrev_b32 v72, 4, v0
    v_mul_u32_u24 v72, 4160, v72
    v_and_b32 v60, 15, v0
    v_lshl_add_u32 v72, v60, 2, v72
    v_add_u32 v72, s69, v72
    s_waitcnt vmcnt(0)
    ds_write_b32 v72, v61
    v_mov_b32 v62, 90624
    s_cmp_lg_u32 s33, 4
    s_cbranch_scc1 AXZ_20
    ds_write_b16 v62, v64 offset:25310
    ds_write_b16 v62, v64 offset:51102
AXZ_20:
    s_waitcnt lgkmcnt(0)
    s_barrier
    s_barrier
    s_cmp_lg_u32 s33, 4
    s_cbranch_scc1 AXW_21
    v_mov_b32 v250, s83
    s_lshl_b32 s34, s2, 7
    s_add_u32 s34, s34, 32768
    v_mov_b32 v251, s34
    v_cmp_eq_u32 vcc, 0, v0
    s_and_saveexec_b64 s[34:35], vcc
    buffer_store_dword v250, v251, s[84:87], 0 offen sc1
    s_mov_b64 exec, s[34:35]
AXW_21:
    s_cmp_eq_u32 s33, 4
    s_cbranch_scc1 AXQ_22
    s_sub_u32 s38, s32, 1
    s_lshr_b32 s35, s38, 2
    s_and_b32 s34, s38, 3
    s_mul_i32 s36, s34, 11
    s_add_u32 s36, s36, s35
    s_lshl_b32 m0, s36, 11
    s_add_u32 s35, s35, s73
    s_cmp_ge_u32 s35, 28
    s_cselect_b32 s36, 28, 0
    s_sub_u32 s35, s35, s36
    s_mul_i32 s34, s34, 28
    s_add_u32 s34, s34, s35
    s_lshl_b32 s74, s34, 14
    buffer_load_dwordx4 v68, s[52:55], s74 offen lds
    buffer_load_dwordx4 v69, s[52:55], s74 offen offset:1024 lds
    s_add_u32 s38, s38, 3
    s_lshr_b32 s35, s38, 2
    s_and_b32 s34, s38, 3
    s_mul_i32 s36, s34, 11
    s_add_u32 s36, s36, s35
    s_lshl_b32 m0, s36, 11
    s_add_u32 s35, s35, s73
    s_cmp_ge_u32 s35, 28
    s_cselect_b32 s36, 28, 0
    s_sub_u32 s35, s35, s36
    s_mul_i32 s34, s34, 28
    s_add_u32 s34, s34, s35
    s_lshl_b32 s74, s34, 14
    buffer_load_dwordx4 v68, s[52:55], s74 offen lds
    buffer_load_dwordx4 v69, s[52:55], s74 offen offset:1024 lds
    s_add_u32 s38, s38, 3
    s_lshr_b32 s35, s38, 2
    s_and_b32 s34, s38, 3
    s_mul_i32 s36, s34, 11
    s_add_u32 s36, s36, s35
    s_lshl_b32 m0, s36, 11
    s_add_u32 s35, s35, s73
    s_cmp_ge_u32 s35, 28
    s_cselect_b32 s36, 28, 0
    s_sub_u32 s35, s35, s36
    s_mul_i32 s34, s34, 28
    s_add_u32 s34, s34, s35
    s_lshl_b32 s74, s34, 14
    buffer_load_dwordx4 v68, s[52:55], s74 offen lds
    buffer_load_dwordx4 v69, s[52:55], s74 offen offset:1024 lds
    s_add_u32 s38, s38, 3
    s_lshr_b32 s35, s38, 2
    s_and_b32 s34, s38, 3
    s_mul_i32 s36, s34, 11
    s_add_u32 s36, s36, s35
    s_lshl_b32 m0, s36, 11
    s_add_u32 s35, s35, s73
    s_cmp_ge_u32 s35, 28
    s_cselect_b32 s36, 28, 0
    s_sub_u32 s35, s35, s36
    s_mul_i32 s34, s34, 28
    s_add_u32 s34, s34, s35
    s_lshl_b32 s74, s34, 14
    buffer_load_dwordx4 v68, s[52:55], s74 offen lds
    buffer_load_dwordx4 v69, s[52:55], s74 offen offset:1024 lds
    s_add_u32 s38, s38, 3
    s_lshr_b32 s35, s38, 2
    s_and_b32 s34, s38, 3
    s_mul_i32 s36, s34, 11
    s_add_u32 s36, s36, s35
    s_lshl_b32 m0, s36, 11
    s_add_u32 s35, s35, s73
    s_cmp_ge_u32 s35, 28
    s_cselect_b32 s36, 28, 0
    s_sub_u32 s35, s35, s36
    s_mul_i32 s34, s34, 28
    s_add_u32 s34, s34, s35
    s_lshl_b32 s74, s34, 14
    buffer_load_dwordx4 v68, s[52:55], s74 offen lds
    buffer_load_dwordx4 v69, s[52:55], s74 offen offset:1024 lds
    s_add_u32 s38, s38, 3
    s_lshr_b32 s35, s38, 2
    s_and_b32 s34, s38, 3
    s_mul_i32 s36, s34, 11
    s_add_u32 s36, s36, s35
    s_lshl_b32 m0, s36, 11
    s_add_u32 s35, s35, s73
    s_cmp_ge_u32 s35, 28
    s_cselect_b32 s36, 28, 0
    s_sub_u32 s35, s35, s36
    s_mul_i32 s34, s34, 28
    s_add_u32 s34, s34, s35
    s_lshl_b32 s74, s34, 14
    buffer_load_dwordx4 v68, s[52:55], s74 offen lds
    buffer_load_dwordx4 v69, s[52:55], s74 offen offset:1024 lds
    s_add_u32 s38, s38, 3
    s_lshr_b32 s35, s38, 2
    s_and_b32 s34, s38, 3
    s_mul_i32 s36, s34, 11
    s_add_u32 s36, s36, s35
    s_lshl_b32 m0, s36, 11
    s_add_u32 s35, s35, s73
    s_cmp_ge_u32 s35, 28
    s_cselect_b32 s36, 28, 0
    s_sub_u32 s35, s35, s36
    s_mul_i32 s34, s34, 28
    s_add_u32 s34, s34, s35
    s_lshl_b32 s74, s34, 14
    buffer_load_dwordx4 v68, s[52:55], s74 offen lds
    buffer_load_dwordx4 v69, s[52:55], s74 offen offset:1024 lds
    s_add_u32 s38, s38, 3
    s_lshr_b32 s35, s38, 2
    s_and_b32 s34, s38, 3
    s_mul_i32 s36, s34, 11
    s_add_u32 s36, s36, s35
    s_lshl_b32 m0, s36, 11
    s_add_u32 s35, s35, s73
    s_cmp_ge_u32 s35, 28
    s_cselect_b32 s36, 28, 0
    s_sub_u32 s35, s35, s36
    s_mul_i32 s34, s34, 28
    s_add_u32 s34, s34, s35
    s_lshl_b32 s74, s34, 14
    buffer_load_dwordx4 v68, s[52:55], s74 offen lds
    buffer_load_dwordx4 v69, s[52:55], s74 offen offset:1024 lds
    s_add_u32 s38, s38, 3
    s_lshr_b32 s35, s38, 2
    s_and_b32 s34, s38, 3
    s_mul_i32 s36, s34, 11
    s_add_u32 s36, s36, s35
    s_lshl_b32 m0, s36, 11
    s_add_u32 s35, s35, s73
    s_cmp_ge_u32 s35, 28
    s_cselect_b32 s36, 28, 0
    s_sub_u32 s35, s35, s36
    s_mul_i32 s34, s34, 28
    s_add_u32 s34, s34, s35
    s_lshl_b32 s74, s34, 14
    buffer_load_dwordx4 v68, s[52:55], s74 offen lds
    buffer_load_dwordx4 v69, s[52:55], s74 offen offset:1024 lds
    s_add_u32 s38, s38, 3
    s_cmp_ge_u32 s38, 28
    s_cbranch_scc1 AXP_32
    s_lshr_b32 s35, s38, 2
    s_and_b32 s34, s38, 3
    s_mul_i32 s36, s34, 11
    s_add_u32 s36, s36, s35
    s_lshl_b32 m0, s36, 11
    s_add_u32 s35, s35, s73
    s_cmp_ge_u32 s35, 28
    s_cselect_b32 s36, 28, 0
    s_sub_u32 s35, s35, s36
    s_mul_i32 s34, s34, 28
    s_add_u32 s34, s34, s35
    s_lshl_b32 s74, s34, 14
    buffer_load_dwordx4 v68, s[52:55], s74 offen lds
    buffer_load_dwordx4 v69, s[52:55], s74 offen offset:1024 lds
    s_add_u32 s38, s38, 3
AXP_32:
AXQ_22:
    s_barrier
    s_cmp_lg_u32 s33, 4
    s_cbranch_scc1 AXW_33
    s_lshr_b32 s34, s71, 1
    s_lshr_b32 s35, s34, 3
    s_and_b32 s34, s34, 7
    s_lshl_b32 s34, s34, 3
    s_add_u32 s34, s34, s35
    v_and_b32 v63, 3, v0
    v_lshlrev_b32 v63, 1, v63
    v_bfe_u32 v62, v0, 2, 2
    v_lshl_add_u32 v63, v62, 6, v63
    v_add_u32 v63, s34, v63
    v_lshlrev_b32 v253, 7, v63
    v_add_u32 v253, 32768, v253
    s_mov_b32 s36, 4194304
POLL_34:
    buffer_load_dword v252, v253, s[84:87], 0 offen sc1
    s_waitcnt vmcnt(0)
    v_cmp_eq_u32 vcc, s83, v252
    s_nop 1
    s_cmp_eq_u64 vcc, exec
    s_cbranch_scc1 POLLOK_35
    s_sub_u32 s36, s36, 1
    s_cmp_lg_u32 s36, 0
    s_cbranch_scc1 POLL_34
POLLOK_35:
AXW_33:
    s_waitcnt vmcnt(10)
    s_barrier
    s_waitcnt vmcnt(0)
    s_barrier
    s_cmp_lg_u32 s33, 4
    s_cbranch_scc1 AX_36
    v_mov_b32 v250, s83
    s_lshl_b32 s34, s2, 7
    s_add_u32 s34, s34, 65536
    v_mov_b32 v251, s34
    v_cmp_eq_u32 vcc, 0, v0
    s_and_saveexec_b64 s[34:35], vcc
    buffer_store_dword v250, v251, s[84:87], 0 offen sc1
    s_mov_b64 exec, s[34:35]
    v_and_b32 v63, 31, v0
    v_lshlrev_b32 v63, 3, v63
    v_add_u32 v63, s72, v63
    v_lshlrev_b32 v253, 7, v63
    v_add_u32 v253, 65536, v253
    s_mov_b32 s36, 4194304
POLL_37:
    buffer_load_dword v252, v253, s[84:87], 0 offen sc1
    s_waitcnt vmcnt(0)
    v_cmp_eq_u32 vcc, s83, v252
    s_nop 1
    s_cmp_eq_u64 vcc, exec
    s_cbranch_scc1 POLLOK_38
    s_sleep 2
    s_sub_u32 s36, s36, 1
    s_cmp_lg_u32 s36, 0
    s_cbranch_scc1 POLL_37
POLLOK_38:
    s_add_u32 s56, s30, 10485760
    s_addc_u32 s57, s31, 0
    s_mov_b32 s58, 2097152
    s_mov_b32 s59, 0x20000
    v_lshrrev_b32 v70, 3, v0
    v_bfe_u32 v71, v0, 4, 1
    v_lshlrev_b32 v71, 2, v71
    v_and_b32 v73, 7, v0
    v_xor_b32 v73, v73, v71
    v_lshlrev_b32 v73, 4, v73
    v_lshl_add_u32 v73, v70, 12, v73
    s_lshl_b32 s34, s72, 18
    s_lshl_b32 s35, s71, 7
    s_add_u32 s34, s34, s35
    s_mov_b32 m0, 142336
    s_nop 0
    buffer_load_dwordx4 v73, s[56:59], s34 offen sc1 lds
    s_add_u32 s34, s34, 32768
    s_mov_b32 m0, 143360
    s_nop 0
    buffer_load_dwordx4 v73, s[56:59], s34 offen sc1 lds
    s_add_u32 s34, s34, 32768
    s_mov_b32 m0, 144384
    s_nop 0
    buffer_load_dwordx4 v73, s[56:59], s34 offen sc1 lds
    s_add_u32 s34, s34, 32768
    s_mov_b32 m0, 145408
    s_nop 0
    buffer_load_dwordx4 v73, s[56:59], s34 offen sc1 lds
    s_add_u32 s34, s34, 32768
    s_mov_b32 m0, 146432
    s_nop 0
    buffer_load_dwordx4 v73, s[56:59], s34 offen sc1 lds
    s_add_u32 s34, s34, 32768
    s_mov_b32 m0, 147456
    s_nop 0
    buffer_load_dwordx4 v73, s[56:59], s34 offen sc1 lds
    s_add_u32 s34, s34, 32768
    s_mov_b32 m0, 148480
    s_nop 0
    buffer_load_dwordx4 v73, s[56:59], s34 offen sc1 lds
    s_add_u32 s34, s34, 32768
    s_mov_b32 m0, 149504
    s_nop 0
    buffer_load_dwordx4 v73, s[56:59], s34 offen sc1 lds
    s_add_u32 s34, s34, 32768
    s_waitcnt vmcnt(0)
AX_36:
    s_barrier
L_fin:
L_end:
    s_endpgm
.section .rodata,"a"
.p2align 6
.amdhsa_kernel gated_mix__ssm_conv_h3__glu_gated_geglu__prompt_kernel
  .amdhsa_next_free_vgpr 256
  .amdhsa_next_free_sgpr 102
  .amdhsa_accum_offset 256
  .amdhsa_group_segment_fixed_size 0
  .amdhsa_kernarg_size 112
  .amdhsa_user_sgpr_count 2
  .amdhsa_user_sgpr_kernarg_segment_ptr 1
  .amdhsa_system_sgpr_workgroup_id_x 1
.end_amdhsa_kernel
.text
```
